```python
import torch

def _softmax(x, axis=-1):
    return torch.softmax(x, dim=axis)
def _gelu(x):
    return torch.nn.functional.gelu(x, approximate="tanh")
def _silu(x):
    return torch.nn.functional.silu(x)
def _sigmoid(x):
    return torch.sigmoid(x)
def _layernorm(x, axis=-1, eps=1e-5):
    m = x.mean(dim=axis, keepdim=True)
    v = x.var(dim=axis, keepdim=True, unbiased=False)
    return (x - m) / torch.sqrt(v + eps)
def _scatter_add(tgt, idx, src, axis=0):
    return tgt.clone().index_add_(axis, idx, src)
def _segment_sum(src, seg, n):
    out = torch.zeros((n,) + src.shape[1:], dtype=src.dtype)
    return out.index_add_(0, seg, src)
def _pad(x, pw):
    flat = tuple(v for pair in reversed(pw) for v in pair)
    return torch.nn.functional.pad(x, flat)

kernel_name = 'standalone__mha_block_cached__near_ridge'

def setup_inputs():

    _w = (lambda a: (lambda t: t.to(torch.bfloat16) if t.is_floating_point() else t)(torch.as_tensor(a)))
    B, Sq, D = 16, 128, 512
    H, Sk, Dh = 32, 512, 128
    return {
        "x": _w((lambda *s: torch.randn(*s, dtype=torch.bfloat16) * 0.8)(B, Sq, D)),
        "k_cache": _w((lambda *s: torch.randn(*s, dtype=torch.bfloat16) * 0.8)(B, H, Sk, Dh)),
        "v_cache": _w((lambda *s: torch.randn(*s, dtype=torch.bfloat16) * 0.05)(B, H, Sk, Dh)),
        "wq": _w((lambda *s: torch.randn(*s, dtype=torch.bfloat16) * 0.8)(D, H * Dh) * (D ** -0.5)),
        "wo": _w((lambda *s: torch.randn(*s, dtype=torch.bfloat16) * 0.05)(H * Dh, D) * ((H * Dh) ** -0.5)),
    }

def reference(x, k_cache, v_cache, wq, wo):
    B, Sq, D = x.shape
    H, Dh = 32, 128
    q = (lambda x, *d: x.permute(*d))((x @ wq).reshape(B, Sq, H, Dh), 0, 2, 1, 3)
    scores = torch.einsum("bhqd,bhkd->bhqk", q, k_cache) * (Dh ** -0.5)
    p = _softmax(scores, axis=-1)
    o = torch.einsum("bhqk,bhkd->bhqd", p, v_cache)
    return (lambda x, *d: x.permute(*d))(o, 0, 2, 1, 3).reshape(B, Sq, H * Dh) @ wo
```

```asm
; @launch grid=(256,1,1) block=(512,1,1) lds=163840
.amdgcn_target "amdgcn-amd-amdhsa--gfx950"
.text
.globl standalone__mha_block_cached__near_ridge_kernel
.p2align 8
.type standalone__mha_block_cached__near_ridge_kernel,@function
standalone__mha_block_cached__near_ridge_kernel:
  s_cmp_ge_u32 s2, 256
  s_cbranch_scc1 L_exit
  s_load_dwordx16 s[76:91], s[0:1], 0
  v_lshrrev_b32 v1, 6, v0
  s_nop 0
  v_readfirstlane_b32 s3, v1
  v_and_b32 v0, 63, v0
  s_cmp_ge_u32 s3, 4
  s_cbranch_scc1 L_nocpf
  s_getpc_b64 s[96:97]
L_pc:
  s_sub_u32 s96, s96, L_pc-standalone__mha_block_cached__near_ridge_kernel
  s_subb_u32 s97, s97, 0
  s_lshl_b32 s38, s3, 6
  s_load_dword s101, s[96:97], s38 offset:256
  s_load_dword s101, s[96:97], s38 offset:512
  s_load_dword s101, s[96:97], s38 offset:768
  s_load_dword s101, s[96:97], s38 offset:1024
  s_load_dword s101, s[96:97], s38 offset:1280
  s_load_dword s101, s[96:97], s38 offset:1536
  s_load_dword s101, s[96:97], s38 offset:1792
  s_load_dword s101, s[96:97], s38 offset:2048
  s_lshr_b32 s39, s2, 3
  s_lshl_b32 s39, s39, 8
  s_add_u32 s38, s38, s39
  s_load_dword s101, s[96:97], s38 offset:0
  s_load_dword s101, s[96:97], s38 offset:8192
  s_load_dword s101, s[96:97], s38 offset:16384
  s_load_dword s101, s[96:97], s38 offset:24576
  s_min_u32 s38, s38, L_exit-standalone__mha_block_cached__near_ridge_kernel-32768
  s_load_dword s101, s[96:97], s38 offset:32768
L_nocpf:
  s_bfe_u32 s71, s2, 196611
  s_and_b32 s38, s2, 1
  s_lshl_b32 s38, s38, 3
  s_add_u32 s36, s38, s71
  s_bfe_u32 s63, s2, 131073
  s_lshr_b32 s69, s2, 6
  s_lshl_b32 s38, s63, 3
  s_add_u32 s37, s38, s69
  s_and_b32 s47, s3, 3
  s_lshl_b32 s68, s47, 12
  s_lshl_b32 s59, s36, 17
  s_lshl_b32 s60, s37, 8
  s_add_u32 s38, s71, s69
  s_and_b32 s38, s38, 1
  s_lshl_b32 s48, s38, 2
  s_cmp_lt_u32 s3, 4
  s_cbranch_scc1 L_A
  v_lshrrev_b32 v32, 3, v0
  v_and_b32 v33, 7, v0
  v_bfe_u32 v34, v0, 4, 1
  v_lshrrev_b32 v35, 4, v0
  v_bfe_u32 v36, v0, 3, 2
  v_lshrrev_b32 v37, 5, v0
  v_lshlrev_b32 v38, 2, v34
  v_xor_b32 v38, v38, v33
  v_lshlrev_b32 v38, 4, v38
  s_lshl_b32 s38, s47, 15
  v_add_u32 v39, 0, v35
  v_and_b32 v39, 7, v39
  v_xor_b32 v39, v39, v33
  v_lshlrev_b32 v39, 4, v39
  v_lshl_add_u32 v39, v32, 10, v39
  v_add_u32 v39, 0, v39
  v_add_u32 v8, s38, v39
  v_add_u32 v39, 4, v35
  v_and_b32 v39, 7, v39
  v_xor_b32 v39, v39, v33
  v_lshlrev_b32 v39, 4, v39
  v_lshl_add_u32 v39, v32, 10, v39
  v_add_u32 v39, 7168, v39
  v_add_u32 v9, s38, v39
  v_add_u32 v39, 8, v35
  v_and_b32 v39, 7, v39
  v_xor_b32 v39, v39, v33
  v_lshlrev_b32 v39, 4, v39
  v_lshl_add_u32 v39, v32, 10, v39
  v_add_u32 v39, 14336, v39
  v_add_u32 v10, s38, v39
  v_add_u32 v39, 12, v35
  v_and_b32 v39, 7, v39
  v_xor_b32 v39, v39, v33
  v_lshlrev_b32 v39, 4, v39
  v_lshl_add_u32 v39, v32, 10, v39
  v_add_u32 v39, 21504, v39
  v_add_u32 v11, s38, v39
  v_lshl_add_u32 v39, v36, 13, v38
  v_lshl_add_u32 v39, v37, 7, v39
  s_lshl_b32 s38, s47, 17
  v_add_u32 v39, s38, v39
  v_add_u32 v12, 0, v39
  v_add_u32 v13, 31744, v39
  v_add_u32 v14, 63488, v39
  v_add_u32 v15, 95232, v39
  s_waitcnt lgkmcnt(0)
  s_mov_b32 s8, s76
  s_and_b32 s9, s77, 0xffff
  s_mov_b32 s10, 2097152
  s_mov_b32 s11, 0x20000
  s_mov_b32 s20, s82
  s_and_b32 s21, s83, 0xffff
  s_mov_b32 s22, 4194304
  s_mov_b32 s23, 0x20000
  s_nop 1
  s_add_u32 s39, s48, 0
  s_and_b32 s39, s39, 7
  s_lshl_b32 s54, s39, 7
  s_add_u32 s54, s54, s59
  s_add_u32 m0, s68, 0
  s_nop 0
  buffer_load_dwordx4 v8, s[8:11], s54 offen offset:0  lds
  buffer_load_dwordx4 v9, s[8:11], s54 offen offset:1024  lds
  buffer_load_dwordx4 v10, s[8:11], s54 offen offset:2048  lds
  buffer_load_dwordx4 v11, s[8:11], s54 offen offset:3072  lds
  s_add_u32 s39, s48, 0
  s_and_b32 s39, s39, 7
  s_lshl_b32 s54, s39, 19
  s_add_u32 s54, s54, s60
  s_add_u32 m0, s68, 16384
  s_nop 0
  buffer_load_dwordx4 v12, s[20:23], s54 offen offset:0  lds
  buffer_load_dwordx4 v13, s[20:23], s54 offen offset:1024  lds
  buffer_load_dwordx4 v14, s[20:23], s54 offen offset:2048  lds
  buffer_load_dwordx4 v15, s[20:23], s54 offen offset:3072  lds
  s_add_u32 s39, s48, 0
  s_and_b32 s39, s39, 7
  s_lshl_b32 s54, s39, 19
  s_add_u32 s54, s54, s60
  s_xor_b32 s54, s54, 1024
  s_add_u32 m0, s68, 32768
  s_nop 0
  buffer_load_dwordx4 v12, s[20:23], s54 offen offset:0  lds
  buffer_load_dwordx4 v13, s[20:23], s54 offen offset:1024  lds
  buffer_load_dwordx4 v14, s[20:23], s54 offen offset:2048  lds
  buffer_load_dwordx4 v15, s[20:23], s54 offen offset:3072  lds
  s_add_u32 s39, s48, 1
  s_and_b32 s39, s39, 7
  s_lshl_b32 s54, s39, 7
  s_add_u32 s54, s54, s59
  s_add_u32 m0, s68, 49152
  s_nop 0
  buffer_load_dwordx4 v8, s[8:11], s54 offen offset:0  lds
  buffer_load_dwordx4 v9, s[8:11], s54 offen offset:1024  lds
  buffer_load_dwordx4 v10, s[8:11], s54 offen offset:2048  lds
  buffer_load_dwordx4 v11, s[8:11], s54 offen offset:3072  lds
  s_add_u32 s39, s48, 1
  s_and_b32 s39, s39, 7
  s_lshl_b32 s54, s39, 19
  s_add_u32 s54, s54, s60
  s_add_u32 m0, s68, 65536
  s_nop 0
  buffer_load_dwordx4 v12, s[20:23], s54 offen offset:0  lds
  buffer_load_dwordx4 v13, s[20:23], s54 offen offset:1024  lds
  buffer_load_dwordx4 v14, s[20:23], s54 offen offset:2048  lds
  buffer_load_dwordx4 v15, s[20:23], s54 offen offset:3072  lds
  s_mov_b32 s12, s78
  s_and_b32 s13, s79, 0xffff
  s_mov_b32 s14, 67108864
  s_mov_b32 s15, 0x20000
  s_mov_b32 s16, s80
  s_and_b32 s17, s81, 0xffff
  s_mov_b32 s18, 67108864
  s_mov_b32 s19, 0x20000
  s_mov_b32 s24, s84
  s_and_b32 s25, s85, 0xffff
  s_mov_b32 s26, 4194304
  s_mov_b32 s27, 0x20000
  s_mov_b32 s28, s86
  s_and_b32 s29, s87, 0xffff
  s_mov_b32 s30, 2097152
  s_mov_b32 s31, 0x20000
  s_mov_b32 s4, s88
  s_and_b32 s5, s89, 0xffff
  s_mov_b32 s6, 256
  s_mov_b32 s7, 0x20000
  s_mov_b32 s32, s90
  s_and_b32 s33, s91, 0xffff
  s_mov_b32 s34, 268435456
  s_mov_b32 s35, 0x20000
  s_mov_b32 s99, 0
  s_and_b32 s70, s71, 0
  s_mul_i32 s55, s2, s2
  s_add_u32 s55, s55, s2
  s_mul_i32 s55, s55, 0x27d4eb2f
  s_lshr_b32 s55, s55, 29
  s_lshl_b32 s38, s36, 5
  s_add_u32 s38, s38, s37
  s_lshl_b32 s61, s38, 17
  s_lshl_b32 s62, s38, 15
  s_cmp_lg_u32 s3, 4
  s_cbranch_scc1 L_G_norstc0
  s_lshl_b32 s38, s36, 2
  s_add_u32 s38, s38, s63
  s_lshl_b32 s38, s38, 11
  s_lshl_b32 s39, s69, 2
  s_add_u32 s38, s38, s39
  s_add_u32 s38, s38, 50331648
  v_lshlrev_b32 v48, 7, v0
  v_add_u32 v48, s38, v48
  s_lshl_b32 s38, s36, 2
  s_add_u32 s38, s38, s69
  s_lshl_b32 s38, s38, 11
  s_lshl_b32 s39, s63, 2
  s_add_u32 s38, s38, s39
  s_add_u32 s38, s38, 51378176
  v_lshlrev_b32 v49, 7, v0
  v_add_u32 v49, s38, v49
  v_cmp_gt_u32 vcc, 16, v0
  s_nop 1
  v_cndmask_b32 v48, v49, v48, vcc
  v_mov_b32 v49, 0
  s_mov_b64 s[52:53], exec
  s_mov_b32 exec_hi, 0
  buffer_store_dword v49, v48, s[32:35], 0 offen sc1
  s_mov_b64 exec, s[52:53]
L_G_norstc0:
  v_lshrrev_b32 v32, 3, v0
  v_and_b32 v33, 7, v0
  v_bfe_u32 v34, v0, 4, 1
  v_lshrrev_b32 v35, 4, v0
  v_bfe_u32 v36, v0, 3, 2
  v_lshrrev_b32 v37, 5, v0
  v_lshlrev_b32 v38, 2, v34
  v_xor_b32 v38, v38, v33
  v_lshlrev_b32 v38, 4, v38
  v_add_u32 v39, 0, v34
  v_xor_b32 v39, v39, v33
  v_lshlrev_b32 v39, 4, v39
  v_lshl_add_u32 v39, v36, 8, v39
  v_lshl_add_u32 v39, v37, 7, v39
  v_add_u32 v16, s68, v39
  v_add_u32 v39, 2, v34
  v_xor_b32 v39, v39, v33
  v_lshlrev_b32 v39, 4, v39
  v_lshl_add_u32 v39, v36, 8, v39
  v_lshl_add_u32 v39, v37, 7, v39
  v_add_u32 v17, s68, v39
  v_add_u32 v39, 4, v34
  v_xor_b32 v39, v39, v33
  v_lshlrev_b32 v39, 4, v39
  v_lshl_add_u32 v39, v36, 8, v39
  v_lshl_add_u32 v39, v37, 7, v39
  v_add_u32 v18, s68, v39
  v_add_u32 v39, 6, v34
  v_xor_b32 v39, v39, v33
  v_lshlrev_b32 v39, 4, v39
  v_lshl_add_u32 v39, v36, 8, v39
  v_lshl_add_u32 v39, v37, 7, v39
  v_add_u32 v19, s68, v39
  v_lshl_add_u32 v39, v36, 8, v38
  v_lshl_add_u32 v39, v37, 7, v39
  v_add_u32 v20, s68, v39
  v_lshrrev_b32 v32, 3, v0
  v_and_b32 v33, 7, v0
  v_bfe_u32 v34, v0, 4, 1
  v_lshrrev_b32 v35, 4, v0
  v_bfe_u32 v36, v0, 3, 2
  v_lshrrev_b32 v37, 5, v0
  v_lshlrev_b32 v38, 2, v34
  v_xor_b32 v38, v38, v33
  v_lshlrev_b32 v38, 4, v38
  v_lshl_add_u32 v39, v36, 10, v38
  v_lshl_add_u32 v39, v37, 7, v39
  s_lshl_b32 s38, s47, 14
  v_add_u32 v39, s38, v39
  v_add_u32 v24, 0, v39
  v_add_u32 v25, 3072, v39
  v_add_u32 v26, 6144, v39
  v_add_u32 v27, 9216, v39
  v_lshlrev_b32 v28, 4, v0
  v_and_b32 v39, 3, v0
  v_lshlrev_b32 v29, 2, v39
  s_lshl_b32 s49, s63, 20
  s_lshl_b32 s38, s69, 8
  s_add_u32 s49, s49, s38
  s_lshl_b32 s50, s36, 20
  s_lshl_b32 s38, s63, 18
  s_add_u32 s50, s50, s38
  s_add_u32 s50, s50, s68
  s_lshl_b32 s38, s36, 2
  s_add_u32 s38, s38, s63
  s_lshl_b32 s38, s38, 11
  s_lshl_b32 s39, s47, 7
  s_add_u32 s38, s38, s39
  s_add_u32 s46, s38, 50331648
  s_lshl_b32 s39, s69, 2
  s_add_u32 s45, s46, s39
  s_mov_b32 s66, 0x3e0293ee
  v_bfe_u32 v41, v0, 2, 2
  v_bfe_u32 v40, v0, 3, 1
  v_lshlrev_b32 v40, 6, v40
  v_lshl_add_u32 v40, v41, 7, v40
  v_bfe_u32 v42, v0, 4, 1
  v_lshl_add_u32 v40, v42, 5, v40
  v_and_b32 v42, 1, v0
  v_lshl_add_u32 v40, v42, 4, v40
  v_bfe_u32 v42, v0, 1, 1
  v_lshl_add_u32 v40, v42, 3, v40
  v_lshrrev_b32 v43, 5, v0
  v_lshl_add_u32 v7, v43, 10, v40
  s_and_b32 s38, s47, 1
  s_lshl_b32 s38, s38, 6
  v_xor_b32 v7, s38, v7
  s_lshr_b32 s38, s47, 1
  s_lshl_b32 s38, s38, 9
  v_add_u32 v7, s38, v7
  v_lshlrev_b32 v39, 4, v0
  v_lshl_add_u32 v5, v43, 11, v40
  v_xor_b32 v6, 64, v5
  v_bfe_u32 v42, v0, 1, 3
  v_xor_b32 v42, v42, v43
  v_lshlrev_b32 v42, 4, v42
  v_and_b32 v40, 31, v0
  v_lshlrev_b32 v40, 7, v40
  v_add3_u32 v1, v40, v42, s68
  v_xor_b32 v2, 32, v1
  v_xor_b32 v3, 64, v1
  v_xor_b32 v4, 96, v1
  s_waitcnt vmcnt(12)
  s_barrier
  s_add_u32 s39, s48, 1
  s_and_b32 s39, s39, 7
  s_lshl_b32 s54, s39, 19
  s_add_u32 s54, s54, s60
  s_xor_b32 s54, s54, 1024
  s_add_u32 m0, s68, 81920
  s_nop 0
  buffer_load_dwordx4 v12, s[20:23], s54 offen offset:0  lds
  buffer_load_dwordx4 v13, s[20:23], s54 offen offset:1024  lds
  buffer_load_dwordx4 v14, s[20:23], s54 offen offset:2048  lds
  buffer_load_dwordx4 v15, s[20:23], s54 offen offset:3072  lds
  s_add_u32 s39, s55, 7
  s_and_b32 s39, s39, 7
  s_lshl_b32 s39, s39, 14
  s_add_u32 s54, s61, s39
  buffer_load_dwordx4 v[64:67], v16, s[12:15], s54 offen offset:0 nt
  buffer_load_dwordx4 v[68:71], v17, s[12:15], s54 offen offset:1024 nt
  buffer_load_dwordx4 v[72:75], v18, s[12:15], s54 offen offset:2048 nt
  buffer_load_dwordx4 v[76:79], v19, s[12:15], s54 offen offset:3072 nt
  s_waitcnt vmcnt(16)
  s_barrier
  s_add_u32 s39, s48, 2
  s_and_b32 s39, s39, 7
  s_lshl_b32 s54, s39, 7
  s_add_u32 s54, s54, s59
  s_add_u32 m0, s68, 98304
  s_nop 0
  buffer_load_dwordx4 v8, s[8:11], s54 offen offset:0  lds
  buffer_load_dwordx4 v9, s[8:11], s54 offen offset:1024  lds
  buffer_load_dwordx4 v10, s[8:11], s54 offen offset:2048  lds
  buffer_load_dwordx4 v11, s[8:11], s54 offen offset:3072  lds
  s_waitcnt vmcnt(12)
  s_barrier
  s_add_u32 s39, s48, 2
  s_and_b32 s39, s39, 7
  s_lshl_b32 s54, s39, 19
  s_add_u32 s54, s54, s60
  s_add_u32 m0, s68, 0
  s_nop 0
  buffer_load_dwordx4 v12, s[20:23], s54 offen offset:0  lds
  buffer_load_dwordx4 v13, s[20:23], s54 offen offset:1024  lds
  buffer_load_dwordx4 v14, s[20:23], s54 offen offset:2048  lds
  buffer_load_dwordx4 v15, s[20:23], s54 offen offset:3072  lds
  s_add_u32 s39, s48, 2
  s_and_b32 s39, s39, 7
  s_lshl_b32 s54, s39, 19
  s_add_u32 s54, s54, s60
  s_xor_b32 s54, s54, 1024
  s_add_u32 m0, s68, 16384
  s_nop 0
  buffer_load_dwordx4 v12, s[20:23], s54 offen offset:0  lds
  buffer_load_dwordx4 v13, s[20:23], s54 offen offset:1024  lds
  buffer_load_dwordx4 v14, s[20:23], s54 offen offset:2048  lds
  buffer_load_dwordx4 v15, s[20:23], s54 offen offset:3072  lds
  s_add_u32 s39, s55, 1
  s_and_b32 s39, s39, 7
  s_lshl_b32 s39, s39, 14
  s_add_u32 s54, s61, s39
  s_xor_b32 s54, s54, 524288
  buffer_load_dwordx4 v[80:83], v16, s[12:15], s54 offen offset:0 nt
  buffer_load_dwordx4 v[84:87], v17, s[12:15], s54 offen offset:1024 nt
  buffer_load_dwordx4 v[88:91], v18, s[12:15], s54 offen offset:2048 nt
  buffer_load_dwordx4 v[92:95], v19, s[12:15], s54 offen offset:3072 nt
  s_waitcnt vmcnt(20)
  s_barrier
  s_add_u32 s39, s48, 3
  s_and_b32 s39, s39, 7
  s_lshl_b32 s54, s39, 7
  s_add_u32 s54, s54, s59
  s_add_u32 m0, s68, 32768
  s_nop 0
  buffer_load_dwordx4 v8, s[8:11], s54 offen offset:0  lds
  buffer_load_dwordx4 v9, s[8:11], s54 offen offset:1024  lds
  buffer_load_dwordx4 v10, s[8:11], s54 offen offset:2048  lds
  buffer_load_dwordx4 v11, s[8:11], s54 offen offset:3072  lds
  s_waitcnt vmcnt(12)
  s_barrier
  s_cmp_lg_u32 s3, 4
  s_cbranch_scc1 L_G_nordc0
  v_mov_b32 v49, 1
  s_lshl_b32 s38, s36, 4
  v_mov_b32 v48, s38
  s_mov_b64 s[52:53], exec
  s_mov_b64 exec, 1
  buffer_atomic_add v49, v48, s[4:7], 0 offen sc1
  s_mov_b64 exec, s[52:53]
L_G_nordc0:
  s_add_u32 s39, s48, 3
  s_and_b32 s39, s39, 7
  s_lshl_b32 s54, s39, 19
  s_add_u32 s54, s54, s60
  s_add_u32 m0, s68, 49152
  s_nop 0
  buffer_load_dwordx4 v12, s[20:23], s54 offen offset:0  lds
  buffer_load_dwordx4 v13, s[20:23], s54 offen offset:1024  lds
  buffer_load_dwordx4 v14, s[20:23], s54 offen offset:2048  lds
  buffer_load_dwordx4 v15, s[20:23], s54 offen offset:3072  lds
  s_add_u32 s39, s48, 3
  s_and_b32 s39, s39, 7
  s_lshl_b32 s54, s39, 19
  s_add_u32 s54, s54, s60
  s_xor_b32 s54, s54, 1024
  s_add_u32 m0, s68, 65536
  s_nop 0
  buffer_load_dwordx4 v12, s[20:23], s54 offen offset:0  lds
  buffer_load_dwordx4 v13, s[20:23], s54 offen offset:1024  lds
  buffer_load_dwordx4 v14, s[20:23], s54 offen offset:2048  lds
  buffer_load_dwordx4 v15, s[20:23], s54 offen offset:3072  lds
  s_add_u32 s39, s55, 3
  s_and_b32 s39, s39, 7
  s_lshl_b32 s39, s39, 14
  s_add_u32 s54, s61, s39
  s_xor_b32 s54, s54, 524288
  buffer_load_dwordx4 v[96:99], v16, s[12:15], s54 offen offset:0 nt
  buffer_load_dwordx4 v[100:103], v17, s[12:15], s54 offen offset:1024 nt
  buffer_load_dwordx4 v[104:107], v18, s[12:15], s54 offen offset:2048 nt
  buffer_load_dwordx4 v[108:111], v19, s[12:15], s54 offen offset:3072 nt
  s_waitcnt vmcnt(20)
  s_barrier
  s_add_u32 s39, s48, 4
  s_and_b32 s39, s39, 7
  s_lshl_b32 s54, s39, 7
  s_add_u32 s54, s54, s59
  s_add_u32 m0, s68, 81920
  s_nop 0
  buffer_load_dwordx4 v8, s[8:11], s54 offen offset:0  lds
  buffer_load_dwordx4 v9, s[8:11], s54 offen offset:1024  lds
  buffer_load_dwordx4 v10, s[8:11], s54 offen offset:2048  lds
  buffer_load_dwordx4 v11, s[8:11], s54 offen offset:3072  lds
  s_waitcnt vmcnt(12)
  s_barrier
  s_add_u32 s39, s48, 4
  s_and_b32 s39, s39, 7
  s_lshl_b32 s54, s39, 19
  s_add_u32 s54, s54, s60
  s_add_u32 m0, s68, 98304
  s_nop 0
  buffer_load_dwordx4 v12, s[20:23], s54 offen offset:0  lds
  buffer_load_dwordx4 v13, s[20:23], s54 offen offset:1024  lds
  buffer_load_dwordx4 v14, s[20:23], s54 offen offset:2048  lds
  buffer_load_dwordx4 v15, s[20:23], s54 offen offset:3072  lds
  s_add_u32 s39, s48, 4
  s_and_b32 s39, s39, 7
  s_lshl_b32 s54, s39, 19
  s_add_u32 s54, s54, s60
  s_xor_b32 s54, s54, 1024
  s_add_u32 m0, s68, 0
  s_nop 0
  buffer_load_dwordx4 v12, s[20:23], s54 offen offset:0  lds
  buffer_load_dwordx4 v13, s[20:23], s54 offen offset:1024  lds
  buffer_load_dwordx4 v14, s[20:23], s54 offen offset:2048  lds
  buffer_load_dwordx4 v15, s[20:23], s54 offen offset:3072  lds
  s_add_u32 s39, s55, 5
  s_and_b32 s39, s39, 7
  s_lshl_b32 s39, s39, 14
  s_add_u32 s54, s61, s39
  s_xor_b32 s54, s54, 524288
  buffer_load_dwordx4 v[112:115], v16, s[12:15], s54 offen offset:0 nt
  buffer_load_dwordx4 v[116:119], v17, s[12:15], s54 offen offset:1024 nt
  buffer_load_dwordx4 v[120:123], v18, s[12:15], s54 offen offset:2048 nt
  buffer_load_dwordx4 v[124:127], v19, s[12:15], s54 offen offset:3072 nt
  s_waitcnt vmcnt(20)
  s_barrier
  s_add_u32 s39, s48, 5
  s_and_b32 s39, s39, 7
  s_lshl_b32 s54, s39, 7
  s_add_u32 s54, s54, s59
  s_add_u32 m0, s68, 16384
  s_nop 0
  buffer_load_dwordx4 v8, s[8:11], s54 offen offset:0  lds
  buffer_load_dwordx4 v9, s[8:11], s54 offen offset:1024  lds
  buffer_load_dwordx4 v10, s[8:11], s54 offen offset:2048  lds
  buffer_load_dwordx4 v11, s[8:11], s54 offen offset:3072  lds
  s_waitcnt vmcnt(12)
  s_barrier
  s_add_u32 s39, s48, 5
  s_and_b32 s39, s39, 7
  s_lshl_b32 s54, s39, 19
  s_add_u32 s54, s54, s60
  s_add_u32 m0, s68, 32768
  s_nop 0
  buffer_load_dwordx4 v12, s[20:23], s54 offen offset:0  lds
  buffer_load_dwordx4 v13, s[20:23], s54 offen offset:1024  lds
  buffer_load_dwordx4 v14, s[20:23], s54 offen offset:2048  lds
  buffer_load_dwordx4 v15, s[20:23], s54 offen offset:3072  lds
  s_add_u32 s39, s48, 5
  s_and_b32 s39, s39, 7
  s_lshl_b32 s54, s39, 19
  s_add_u32 s54, s54, s60
  s_xor_b32 s54, s54, 1024
  s_add_u32 m0, s68, 49152
  s_nop 0
  buffer_load_dwordx4 v12, s[20:23], s54 offen offset:0  lds
  buffer_load_dwordx4 v13, s[20:23], s54 offen offset:1024  lds
  buffer_load_dwordx4 v14, s[20:23], s54 offen offset:2048  lds
  buffer_load_dwordx4 v15, s[20:23], s54 offen offset:3072  lds
  s_add_u32 s39, s55, 7
  s_and_b32 s39, s39, 7
  s_lshl_b32 s39, s39, 14
  s_add_u32 s54, s61, s39
  s_xor_b32 s54, s54, 524288
  buffer_load_dwordx4 v[128:131], v16, s[12:15], s54 offen offset:0 nt
  buffer_load_dwordx4 v[132:135], v17, s[12:15], s54 offen offset:1024 nt
  buffer_load_dwordx4 v[136:139], v18, s[12:15], s54 offen offset:2048 nt
  buffer_load_dwordx4 v[140:143], v19, s[12:15], s54 offen offset:3072 nt
  s_waitcnt vmcnt(20)
  s_barrier
  s_add_u32 s39, s48, 6
  s_and_b32 s39, s39, 7
  s_lshl_b32 s54, s39, 7
  s_add_u32 s54, s54, s59
  s_add_u32 m0, s68, 65536
  s_nop 0
  buffer_load_dwordx4 v8, s[8:11], s54 offen offset:0  lds
  buffer_load_dwordx4 v9, s[8:11], s54 offen offset:1024  lds
  buffer_load_dwordx4 v10, s[8:11], s54 offen offset:2048  lds
  buffer_load_dwordx4 v11, s[8:11], s54 offen offset:3072  lds
  s_waitcnt vmcnt(12)
  s_barrier
  s_add_u32 s39, s48, 6
  s_and_b32 s39, s39, 7
  s_lshl_b32 s54, s39, 19
  s_add_u32 s54, s54, s60
  s_add_u32 m0, s68, 81920
  s_nop 0
  buffer_load_dwordx4 v12, s[20:23], s54 offen offset:0  lds
  buffer_load_dwordx4 v13, s[20:23], s54 offen offset:1024  lds
  buffer_load_dwordx4 v14, s[20:23], s54 offen offset:2048  lds
  buffer_load_dwordx4 v15, s[20:23], s54 offen offset:3072  lds
  s_add_u32 s39, s48, 6
  s_and_b32 s39, s39, 7
  s_lshl_b32 s54, s39, 19
  s_add_u32 s54, s54, s60
  s_xor_b32 s54, s54, 1024
  s_add_u32 m0, s68, 98304
  s_nop 0
  buffer_load_dwordx4 v12, s[20:23], s54 offen offset:0  lds
  buffer_load_dwordx4 v13, s[20:23], s54 offen offset:1024  lds
  buffer_load_dwordx4 v14, s[20:23], s54 offen offset:2048  lds
  buffer_load_dwordx4 v15, s[20:23], s54 offen offset:3072  lds
  s_add_u32 s39, s48, 7
  s_and_b32 s39, s39, 7
  s_lshl_b32 s54, s39, 7
  s_add_u32 s54, s54, s59
  s_add_u32 m0, s68, 0
  s_nop 0
  buffer_load_dwordx4 v8, s[8:11], s54 offen offset:0  lds
  buffer_load_dwordx4 v9, s[8:11], s54 offen offset:1024  lds
  buffer_load_dwordx4 v10, s[8:11], s54 offen offset:2048  lds
  buffer_load_dwordx4 v11, s[8:11], s54 offen offset:3072  lds
  s_waitcnt vmcnt(20)
  s_barrier
  s_add_u32 s39, s48, 7
  s_and_b32 s39, s39, 7
  s_lshl_b32 s54, s39, 19
  s_add_u32 s54, s54, s60
  s_add_u32 m0, s68, 16384
  s_nop 0
  buffer_load_dwordx4 v12, s[20:23], s54 offen offset:0  lds
  buffer_load_dwordx4 v13, s[20:23], s54 offen offset:1024  lds
  buffer_load_dwordx4 v14, s[20:23], s54 offen offset:2048  lds
  buffer_load_dwordx4 v15, s[20:23], s54 offen offset:3072  lds
  s_waitcnt vmcnt(12)
  s_barrier
  s_add_u32 s39, s48, 7
  s_and_b32 s39, s39, 7
  s_lshl_b32 s54, s39, 19
  s_add_u32 s54, s54, s60
  s_xor_b32 s54, s54, 1024
  s_add_u32 m0, s68, 32768
  s_nop 0
  buffer_load_dwordx4 v12, s[20:23], s54 offen offset:0  lds
  buffer_load_dwordx4 v13, s[20:23], s54 offen offset:1024  lds
  buffer_load_dwordx4 v14, s[20:23], s54 offen offset:2048  lds
  buffer_load_dwordx4 v15, s[20:23], s54 offen offset:3072  lds
  s_add_u32 s39, s55, 0
  s_and_b32 s39, s39, 7
  s_lshl_b32 s39, s39, 14
  s_add_u32 s54, s61, s39
  s_add_u32 m0, s68, 114688
  s_nop 0
  buffer_load_dwordx4 v16, s[12:15], s54 offen offset:0 nt lds
  buffer_load_dwordx4 v17, s[12:15], s54 offen offset:1024 nt lds
  buffer_load_dwordx4 v18, s[12:15], s54 offen offset:2048 nt lds
  buffer_load_dwordx4 v19, s[12:15], s54 offen offset:3072 nt lds
  s_waitcnt vmcnt(16)
  s_barrier
  s_add_u32 s39, s55, 0
  s_and_b32 s39, s39, 7
  s_lshl_b32 s39, s39, 14
  s_add_u32 s54, s61, s39
  s_add_u32 m0, s68, 131072
  s_nop 0
  buffer_load_dwordx4 v20, s[16:19], s54 offen offset:0 nt lds
  buffer_load_dwordx4 v20, s[16:19], s54 offen offset:1024 nt lds
  buffer_load_dwordx4 v20, s[16:19], s54 offen offset:2048 nt lds
  buffer_load_dwordx4 v20, s[16:19], s54 offen offset:3072 nt lds
  s_waitcnt vmcnt(12)
  s_barrier
  s_add_u32 s39, s55, 1
  s_and_b32 s39, s39, 7
  s_lshl_b32 s39, s39, 14
  s_add_u32 s54, s61, s39
  s_add_u32 m0, s68, 147456
  s_nop 0
  buffer_load_dwordx4 v16, s[12:15], s54 offen offset:0 nt lds
  buffer_load_dwordx4 v17, s[12:15], s54 offen offset:1024 nt lds
  buffer_load_dwordx4 v18, s[12:15], s54 offen offset:2048 nt lds
  buffer_load_dwordx4 v19, s[12:15], s54 offen offset:3072 nt lds
  s_add_u32 s39, s55, 1
  s_and_b32 s39, s39, 7
  s_lshl_b32 s39, s39, 14
  s_add_u32 s54, s61, s39
  s_add_u32 m0, s68, 49152
  s_nop 0
  buffer_load_dwordx4 v20, s[16:19], s54 offen offset:0 nt lds
  buffer_load_dwordx4 v20, s[16:19], s54 offen offset:1024 nt lds
  buffer_load_dwordx4 v20, s[16:19], s54 offen offset:2048 nt lds
  buffer_load_dwordx4 v20, s[16:19], s54 offen offset:3072 nt lds
  s_waitcnt vmcnt(16)
  s_barrier
  s_add_u32 s39, s55, 2
  s_and_b32 s39, s39, 7
  s_lshl_b32 s39, s39, 14
  s_add_u32 s54, s61, s39
  s_add_u32 m0, s68, 65536
  s_nop 0
  buffer_load_dwordx4 v16, s[12:15], s54 offen offset:0 nt lds
  buffer_load_dwordx4 v17, s[12:15], s54 offen offset:1024 nt lds
  buffer_load_dwordx4 v18, s[12:15], s54 offen offset:2048 nt lds
  buffer_load_dwordx4 v19, s[12:15], s54 offen offset:3072 nt lds
  s_waitcnt vmcnt(16)
  s_barrier
  s_waitcnt vmcnt(12)
  s_barrier
  s_add_u32 s39, s55, 2
  s_and_b32 s39, s39, 7
  s_lshl_b32 s39, s39, 14
  s_add_u32 s54, s61, s39
  s_add_u32 m0, s68, 81920
  s_nop 0
  buffer_load_dwordx4 v20, s[16:19], s54 offen offset:0 nt lds
  buffer_load_dwordx4 v20, s[16:19], s54 offen offset:1024 nt lds
  buffer_load_dwordx4 v20, s[16:19], s54 offen offset:2048 nt lds
  buffer_load_dwordx4 v20, s[16:19], s54 offen offset:3072 nt lds
  s_waitcnt vmcnt(12)
  s_barrier
  s_add_u32 s39, s55, 3
  s_and_b32 s39, s39, 7
  s_lshl_b32 s39, s39, 14
  s_add_u32 s54, s61, s39
  s_add_u32 m0, s68, 98304
  s_nop 0
  buffer_load_dwordx4 v16, s[12:15], s54 offen offset:0 nt lds
  buffer_load_dwordx4 v17, s[12:15], s54 offen offset:1024 nt lds
  buffer_load_dwordx4 v18, s[12:15], s54 offen offset:2048 nt lds
  buffer_load_dwordx4 v19, s[12:15], s54 offen offset:3072 nt lds
  s_waitcnt vmcnt(12)
  s_barrier
  s_add_u32 s39, s55, 3
  s_and_b32 s39, s39, 7
  s_lshl_b32 s39, s39, 14
  s_add_u32 s54, s61, s39
  s_add_u32 m0, s68, 0
  s_nop 0
  buffer_load_dwordx4 v20, s[16:19], s54 offen offset:0 nt lds
  buffer_load_dwordx4 v20, s[16:19], s54 offen offset:1024 nt lds
  buffer_load_dwordx4 v20, s[16:19], s54 offen offset:2048 nt lds
  buffer_load_dwordx4 v20, s[16:19], s54 offen offset:3072 nt lds
  s_waitcnt vmcnt(12)
  s_barrier
  s_lshl_b32 s38, s36, 4
  v_mov_b32 v48, 0
  buffer_load_dword v31, v48, s[4:7], s38 offen sc1
  s_add_u32 s39, s55, 4
  s_and_b32 s39, s39, 7
  s_lshl_b32 s39, s39, 14
  s_add_u32 s54, s61, s39
  s_add_u32 m0, s68, 114688
  s_nop 0
  buffer_load_dwordx4 v16, s[12:15], s54 offen offset:0 nt lds
  buffer_load_dwordx4 v17, s[12:15], s54 offen offset:1024 nt lds
  buffer_load_dwordx4 v18, s[12:15], s54 offen offset:2048 nt lds
  buffer_load_dwordx4 v19, s[12:15], s54 offen offset:3072 nt lds
  s_waitcnt vmcnt(13)
  s_barrier
  s_add_u32 s39, s55, 4
  s_and_b32 s39, s39, 7
  s_lshl_b32 s39, s39, 14
  s_add_u32 s54, s61, s39
  s_add_u32 m0, s68, 131072
  s_nop 0
  buffer_load_dwordx4 v20, s[16:19], s54 offen offset:0 nt lds
  buffer_load_dwordx4 v20, s[16:19], s54 offen offset:1024 nt lds
  buffer_load_dwordx4 v20, s[16:19], s54 offen offset:2048 nt lds
  buffer_load_dwordx4 v20, s[16:19], s54 offen offset:3072 nt lds
  s_waitcnt vmcnt(13)
  s_barrier
  s_add_u32 s39, s55, 5
  s_and_b32 s39, s39, 7
  s_lshl_b32 s39, s39, 14
  s_add_u32 s54, s61, s39
  s_add_u32 m0, s68, 147456
  s_nop 0
  buffer_load_dwordx4 v16, s[12:15], s54 offen offset:0 nt lds
  buffer_load_dwordx4 v17, s[12:15], s54 offen offset:1024 nt lds
  buffer_load_dwordx4 v18, s[12:15], s54 offen offset:2048 nt lds
  buffer_load_dwordx4 v19, s[12:15], s54 offen offset:3072 nt lds
  s_waitcnt vmcnt(13)
  s_barrier
  s_add_u32 s39, s55, 5
  s_and_b32 s39, s39, 7
  s_lshl_b32 s39, s39, 14
  s_add_u32 s54, s61, s39
  s_add_u32 m0, s68, 49152
  s_nop 0
  buffer_load_dwordx4 v20, s[16:19], s54 offen offset:0 nt lds
  buffer_load_dwordx4 v20, s[16:19], s54 offen offset:1024 nt lds
  buffer_load_dwordx4 v20, s[16:19], s54 offen offset:2048 nt lds
  buffer_load_dwordx4 v20, s[16:19], s54 offen offset:3072 nt lds
  s_waitcnt vmcnt(12)
  s_barrier
  s_add_u32 s39, s55, 6
  s_and_b32 s39, s39, 7
  s_lshl_b32 s39, s39, 14
  s_add_u32 s54, s61, s39
  s_add_u32 m0, s68, 65536
  s_nop 0
  buffer_load_dwordx4 v16, s[12:15], s54 offen offset:0 nt lds
  buffer_load_dwordx4 v17, s[12:15], s54 offen offset:1024 nt lds
  buffer_load_dwordx4 v18, s[12:15], s54 offen offset:2048 nt lds
  buffer_load_dwordx4 v19, s[12:15], s54 offen offset:3072 nt lds
  s_waitcnt vmcnt(12)
  s_barrier
  s_add_u32 s39, s55, 6
  s_and_b32 s39, s39, 7
  s_lshl_b32 s39, s39, 14
  s_add_u32 s54, s61, s39
  s_add_u32 m0, s68, 81920
  s_nop 0
  buffer_load_dwordx4 v20, s[16:19], s54 offen offset:0 nt lds
  buffer_load_dwordx4 v20, s[16:19], s54 offen offset:1024 nt lds
  buffer_load_dwordx4 v20, s[16:19], s54 offen offset:2048 nt lds
  buffer_load_dwordx4 v20, s[16:19], s54 offen offset:3072 nt lds
  s_waitcnt vmcnt(12)
  s_barrier
  s_add_u32 s39, s55, 7
  s_and_b32 s39, s39, 7
  s_lshl_b32 s39, s39, 14
  s_add_u32 s54, s61, s39
  s_add_u32 m0, s68, 0
  s_nop 0
  buffer_load_dwordx4 v20, s[16:19], s54 offen offset:0 nt lds
  buffer_load_dwordx4 v20, s[16:19], s54 offen offset:1024 nt lds
  buffer_load_dwordx4 v20, s[16:19], s54 offen offset:2048 nt lds
  buffer_load_dwordx4 v20, s[16:19], s54 offen offset:3072 nt lds
  s_waitcnt vmcnt(12)
  s_barrier
  s_add_u32 s39, s55, 0
  s_and_b32 s39, s39, 7
  s_lshl_b32 s39, s39, 14
  s_add_u32 s54, s61, s39
  s_xor_b32 s54, s54, 524288
  s_add_u32 m0, s68, 114688
  s_nop 0
  buffer_load_dwordx4 v16, s[12:15], s54 offen offset:0 nt lds
  buffer_load_dwordx4 v17, s[12:15], s54 offen offset:1024 nt lds
  buffer_load_dwordx4 v18, s[12:15], s54 offen offset:2048 nt lds
  buffer_load_dwordx4 v19, s[12:15], s54 offen offset:3072 nt lds
  s_waitcnt vmcnt(12)
  s_barrier
  s_add_u32 s38, s68, 98304
  v_add_u32 v48, s38, v28
  ds_write_b128 v48, v[64:67] offset:0
  ds_write_b128 v48, v[68:71] offset:1024
  ds_write_b128 v48, v[72:75] offset:2048
  ds_write_b128 v48, v[76:79] offset:3072
  s_add_u32 s39, s55, 0
  s_and_b32 s39, s39, 7
  s_lshl_b32 s39, s39, 14
  s_add_u32 s54, s61, s39
  s_xor_b32 s54, s54, 524288
  s_add_u32 m0, s68, 131072
  s_nop 0
  buffer_load_dwordx4 v20, s[16:19], s54 offen offset:0 nt lds
  buffer_load_dwordx4 v20, s[16:19], s54 offen offset:1024 nt lds
  buffer_load_dwordx4 v20, s[16:19], s54 offen offset:2048 nt lds
  buffer_load_dwordx4 v20, s[16:19], s54 offen offset:3072 nt lds
  s_waitcnt vmcnt(12) lgkmcnt(0)
  s_barrier
  s_add_u32 s39, s55, 1
  s_and_b32 s39, s39, 7
  s_lshl_b32 s39, s39, 14
  s_add_u32 s54, s61, s39
  s_xor_b32 s54, s54, 524288
  s_add_u32 m0, s68, 49152
  s_nop 0
  buffer_load_dwordx4 v20, s[16:19], s54 offen offset:0 nt lds
  buffer_load_dwordx4 v20, s[16:19], s54 offen offset:1024 nt lds
  buffer_load_dwordx4 v20, s[16:19], s54 offen offset:2048 nt lds
  buffer_load_dwordx4 v20, s[16:19], s54 offen offset:3072 nt lds
  s_barrier
  v_cmp_gt_u32 vcc, 16, v31
  s_cbranch_vccz L_dokc0
  s_nop 3
  s_mov_b32 s51, 0x20000
  s_lshl_b32 s38, s36, 4
  v_mov_b32 v32, 0
L_sp_gc0d0:
  buffer_load_dword v30, v32, s[4:7], s38 offen sc1
  s_waitcnt vmcnt(0)
  v_cmp_gt_u32 vcc, 16, v30
  s_cbranch_vccz L_ok_gc0d0
  s_sub_u32 s51, s51, 1
  s_cmp_lg_u32 s51, 0
  s_cbranch_scc1 L_sp_gc0d0
L_ok_gc0d0:
L_dokc0:
  s_waitcnt vmcnt(12)
  s_barrier
  s_add_u32 s39, s55, 2
  s_and_b32 s39, s39, 7
  s_lshl_b32 s39, s39, 14
  s_add_u32 s54, s61, s39
  s_xor_b32 s54, s54, 524288
  s_add_u32 m0, s68, 65536
  s_nop 0
  buffer_load_dwordx4 v16, s[12:15], s54 offen offset:0 nt lds
  buffer_load_dwordx4 v17, s[12:15], s54 offen offset:1024 nt lds
  buffer_load_dwordx4 v18, s[12:15], s54 offen offset:2048 nt lds
  buffer_load_dwordx4 v19, s[12:15], s54 offen offset:3072 nt lds
  s_waitcnt vmcnt(12)
  s_barrier
  s_add_u32 s38, s68, 147456
  v_add_u32 v48, s38, v28
  ds_write_b128 v48, v[80:83] offset:0
  ds_write_b128 v48, v[84:87] offset:1024
  ds_write_b128 v48, v[88:91] offset:2048
  ds_write_b128 v48, v[92:95] offset:3072
  s_add_u32 s39, s55, 2
  s_and_b32 s39, s39, 7
  s_lshl_b32 s39, s39, 14
  s_add_u32 s54, s61, s39
  s_xor_b32 s54, s54, 524288
  s_add_u32 m0, s68, 81920
  s_nop 0
  buffer_load_dwordx4 v20, s[16:19], s54 offen offset:0 nt lds
  buffer_load_dwordx4 v20, s[16:19], s54 offen offset:1024 nt lds
  buffer_load_dwordx4 v20, s[16:19], s54 offen offset:2048 nt lds
  buffer_load_dwordx4 v20, s[16:19], s54 offen offset:3072 nt lds
  s_waitcnt vmcnt(12) lgkmcnt(0)
  s_barrier
  s_add_u32 s39, s55, 3
  s_and_b32 s39, s39, 7
  s_lshl_b32 s39, s39, 14
  s_add_u32 s54, s61, s39
  s_xor_b32 s54, s54, 524288
  s_add_u32 m0, s68, 0
  s_nop 0
  buffer_load_dwordx4 v20, s[16:19], s54 offen offset:0 nt lds
  buffer_load_dwordx4 v20, s[16:19], s54 offen offset:1024 nt lds
  buffer_load_dwordx4 v20, s[16:19], s54 offen offset:2048 nt lds
  buffer_load_dwordx4 v20, s[16:19], s54 offen offset:3072 nt lds
  s_barrier
  s_waitcnt vmcnt(12)
  s_barrier
  s_add_u32 s39, s55, 4
  s_and_b32 s39, s39, 7
  s_lshl_b32 s39, s39, 14
  s_add_u32 s54, s61, s39
  s_xor_b32 s54, s54, 524288
  s_add_u32 m0, s68, 114688
  s_nop 0
  buffer_load_dwordx4 v16, s[12:15], s54 offen offset:0 nt lds
  buffer_load_dwordx4 v17, s[12:15], s54 offen offset:1024 nt lds
  buffer_load_dwordx4 v18, s[12:15], s54 offen offset:2048 nt lds
  buffer_load_dwordx4 v19, s[12:15], s54 offen offset:3072 nt lds
  s_waitcnt vmcnt(12)
  s_barrier
  s_add_u32 s38, s68, 98304
  v_add_u32 v48, s38, v28
  ds_write_b128 v48, v[96:99] offset:0
  ds_write_b128 v48, v[100:103] offset:1024
  ds_write_b128 v48, v[104:107] offset:2048
  ds_write_b128 v48, v[108:111] offset:3072
  s_add_u32 s39, s55, 4
  s_and_b32 s39, s39, 7
  s_lshl_b32 s39, s39, 14
  s_add_u32 s54, s61, s39
  s_xor_b32 s54, s54, 524288
  s_add_u32 m0, s68, 131072
  s_nop 0
  buffer_load_dwordx4 v20, s[16:19], s54 offen offset:0 nt lds
  buffer_load_dwordx4 v20, s[16:19], s54 offen offset:1024 nt lds
  buffer_load_dwordx4 v20, s[16:19], s54 offen offset:2048 nt lds
  buffer_load_dwordx4 v20, s[16:19], s54 offen offset:3072 nt lds
  s_waitcnt vmcnt(12) lgkmcnt(0)
  s_barrier
  s_add_u32 s39, s55, 5
  s_and_b32 s39, s39, 7
  s_lshl_b32 s39, s39, 14
  s_add_u32 s54, s61, s39
  s_xor_b32 s54, s54, 524288
  s_add_u32 m0, s68, 49152
  s_nop 0
  buffer_load_dwordx4 v20, s[16:19], s54 offen offset:0 nt lds
  buffer_load_dwordx4 v20, s[16:19], s54 offen offset:1024 nt lds
  buffer_load_dwordx4 v20, s[16:19], s54 offen offset:2048 nt lds
  buffer_load_dwordx4 v20, s[16:19], s54 offen offset:3072 nt lds
  s_barrier
  s_waitcnt vmcnt(12)
  s_barrier
  s_add_u32 s39, s55, 6
  s_and_b32 s39, s39, 7
  s_lshl_b32 s39, s39, 14
  s_add_u32 s54, s61, s39
  s_xor_b32 s54, s54, 524288
  s_add_u32 m0, s68, 65536
  s_nop 0
  buffer_load_dwordx4 v16, s[12:15], s54 offen offset:0 nt lds
  buffer_load_dwordx4 v17, s[12:15], s54 offen offset:1024 nt lds
  buffer_load_dwordx4 v18, s[12:15], s54 offen offset:2048 nt lds
  buffer_load_dwordx4 v19, s[12:15], s54 offen offset:3072 nt lds
  s_waitcnt vmcnt(12)
  s_barrier
  s_add_u32 s38, s68, 147456
  v_add_u32 v48, s38, v28
  ds_write_b128 v48, v[112:115] offset:0
  ds_write_b128 v48, v[116:119] offset:1024
  ds_write_b128 v48, v[120:123] offset:2048
  ds_write_b128 v48, v[124:127] offset:3072
  s_add_u32 s39, s55, 6
  s_and_b32 s39, s39, 7
  s_lshl_b32 s39, s39, 14
  s_add_u32 s54, s61, s39
  s_xor_b32 s54, s54, 524288
  s_add_u32 m0, s68, 81920
  s_nop 0
  buffer_load_dwordx4 v20, s[16:19], s54 offen offset:0 nt lds
  buffer_load_dwordx4 v20, s[16:19], s54 offen offset:1024 nt lds
  buffer_load_dwordx4 v20, s[16:19], s54 offen offset:2048 nt lds
  buffer_load_dwordx4 v20, s[16:19], s54 offen offset:3072 nt lds
  s_waitcnt vmcnt(12) lgkmcnt(0)
  s_barrier
  s_add_u32 s39, s55, 7
  s_and_b32 s39, s39, 7
  s_lshl_b32 s39, s39, 14
  s_add_u32 s54, s61, s39
  s_xor_b32 s54, s54, 524288
  s_add_u32 m0, s68, 0
  s_nop 0
  buffer_load_dwordx4 v20, s[16:19], s54 offen offset:0 nt lds
  buffer_load_dwordx4 v20, s[16:19], s54 offen offset:1024 nt lds
  buffer_load_dwordx4 v20, s[16:19], s54 offen offset:2048 nt lds
  buffer_load_dwordx4 v20, s[16:19], s54 offen offset:3072 nt lds
  s_add_u32 s39, s71, 0
  s_and_b32 s39, s39, 7
  s_xor_b32 s39, s39, s99
  s_lshl_b32 s54, s39, 16
  s_add_u32 s54, s54, s49
  s_add_u32 m0, s68, 16384
  s_nop 0
  buffer_load_dwordx4 v24, s[24:27], s54 offen offset:0  lds
  buffer_load_dwordx4 v25, s[24:27], s54 offen offset:1024  lds
  buffer_load_dwordx4 v26, s[24:27], s54 offen offset:2048  lds
  buffer_load_dwordx4 v27, s[24:27], s54 offen offset:3072  lds
  s_barrier
  s_waitcnt vmcnt(16)
  s_barrier
  s_add_u32 s39, s71, 1
  s_and_b32 s39, s39, 7
  s_xor_b32 s39, s39, s99
  s_lshl_b32 s54, s39, 16
  s_add_u32 s54, s54, s49
  s_add_u32 m0, s68, 114688
  s_nop 0
  buffer_load_dwordx4 v24, s[24:27], s54 offen offset:0  lds
  buffer_load_dwordx4 v25, s[24:27], s54 offen offset:1024  lds
  buffer_load_dwordx4 v26, s[24:27], s54 offen offset:2048  lds
  buffer_load_dwordx4 v27, s[24:27], s54 offen offset:3072  lds
  s_waitcnt vmcnt(16)
  s_barrier
  s_add_u32 s38, s68, 98304
  v_add_u32 v48, s38, v28
  ds_write_b128 v48, v[128:131] offset:0
  ds_write_b128 v48, v[132:135] offset:1024
  ds_write_b128 v48, v[136:139] offset:2048
  ds_write_b128 v48, v[140:143] offset:3072
  s_add_u32 s39, s71, 2
  s_and_b32 s39, s39, 7
  s_xor_b32 s39, s39, s99
  s_lshl_b32 s54, s39, 16
  s_add_u32 s54, s54, s49
  s_add_u32 m0, s68, 147456
  s_nop 0
  buffer_load_dwordx4 v24, s[24:27], s54 offen offset:0  lds
  buffer_load_dwordx4 v25, s[24:27], s54 offen offset:1024  lds
  buffer_load_dwordx4 v26, s[24:27], s54 offen offset:2048  lds
  buffer_load_dwordx4 v27, s[24:27], s54 offen offset:3072  lds
  s_waitcnt vmcnt(16) lgkmcnt(0)
  s_barrier
  s_add_u32 s38, s46, 512
  buffer_load_dword v30, v29, s[32:35], s38 offen sc1
  s_barrier
  s_waitcnt vmcnt(0)
  v_cmp_ne_u32 vcc, 1, v30
  s_cbranch_vccz L_ok_gc0f1
  s_nop 3
  s_mov_b32 s51, 0x20000
  s_add_u32 s38, s46, 512
L_sp_gc0f1:
  buffer_load_dword v30, v29, s[32:35], s38 offen sc1
  s_waitcnt vmcnt(0)
  v_cmp_ne_u32 vcc, 1, v30
  s_cbranch_vccz L_ok_gc0f1
  s_sub_u32 s51, s51, 1
  s_cmp_lg_u32 s51, 0
  s_cbranch_scc1 L_sp_gc0f1
L_ok_gc0f1:
  s_add_u32 s39, s71, 0
  s_and_b32 s39, s39, 7
  s_xor_b32 s39, s39, s99
  s_lshl_b32 s54, s39, 14
  s_add_u32 s54, s54, s50
  s_add_u32 m0, s68, 32768
  s_nop 0
  buffer_load_dwordx4 v28, s[32:35], s54 offen offset:0 sc1 lds
  buffer_load_dwordx4 v28, s[32:35], s54 offen offset:1024 sc1 lds
  buffer_load_dwordx4 v28, s[32:35], s54 offen offset:2048 sc1 lds
  buffer_load_dwordx4 v28, s[32:35], s54 offen offset:3072 sc1 lds
  s_waitcnt vmcnt(17)
  s_barrier
  s_add_u32 s39, s71, 1
  s_and_b32 s39, s39, 7
  s_xor_b32 s39, s39, s99
  s_lshl_b32 s54, s39, 14
  s_add_u32 s54, s54, s50
  s_add_u32 m0, s68, 131072
  s_nop 0
  buffer_load_dwordx4 v28, s[32:35], s54 offen offset:0 sc1 lds
  buffer_load_dwordx4 v28, s[32:35], s54 offen offset:1024 sc1 lds
  buffer_load_dwordx4 v28, s[32:35], s54 offen offset:2048 sc1 lds
  buffer_load_dwordx4 v28, s[32:35], s54 offen offset:3072 sc1 lds
  s_waitcnt vmcnt(4) lgkmcnt(0)
  s_barrier
  ds_read_b64_tr_b16 v[128:129], v7 offset:16384
  ds_read_b64_tr_b16 v[130:131], v7 offset:18432
  ds_read_b64_tr_b16 v[132:133], v7 offset:20480
  ds_read_b64_tr_b16 v[134:135], v7 offset:22528
  ds_read_b64_tr_b16 v[136:137], v7 offset:24576
  ds_read_b64_tr_b16 v[138:139], v7 offset:26624
  ds_read_b64_tr_b16 v[140:141], v7 offset:28672
  ds_read_b64_tr_b16 v[142:143], v7 offset:30720
  ds_read_b128 v[40:43], v39 offset:32768
  ds_read_b128 v[44:47], v39 offset:36864
  ds_read_b128 v[48:51], v39 offset:40960
  ds_read_b128 v[52:55], v39 offset:45056
  ds_read_b128 v[56:59], v39 offset:33792
  s_waitcnt lgkmcnt(4)
  v_mfma_f32_32x32x16_bf16 v[64:79], v[128:131], v[40:43], 0
  ds_read_b128 v[60:63], v39 offset:37888
  ds_read_b128 v[8:11], v39 offset:41984
  s_waitcnt lgkmcnt(5)
  v_mfma_f32_32x32x16_bf16 v[80:95], v[128:131], v[44:47], 0
  ds_read_b128 v[12:15], v39 offset:46080
  ds_read_b128 v[16:19], v39 offset:34816
  s_waitcnt lgkmcnt(6)
  v_mfma_f32_32x32x16_bf16 v[96:111], v[128:131], v[48:51], 0
  ds_read_b128 v[20:23], v39 offset:38912
  ds_read_b128 v[40:43], v39 offset:43008
  s_waitcnt lgkmcnt(7)
  v_mfma_f32_32x32x16_bf16 v[112:127], v[128:131], v[52:55], 0
  ds_read_b128 v[44:47], v39 offset:47104
  ds_read_b128 v[48:51], v39 offset:35840
  s_waitcnt lgkmcnt(8)
  v_mfma_f32_32x32x16_bf16 v[64:79], v[132:135], v[56:59], v[64:79]
  ds_read_b128 v[52:55], v39 offset:39936
  s_waitcnt lgkmcnt(8)
  v_mfma_f32_32x32x16_bf16 v[80:95], v[132:135], v[60:63], v[80:95]
  ds_read_b128 v[56:59], v39 offset:44032
  s_waitcnt lgkmcnt(8)
  v_mfma_f32_32x32x16_bf16 v[96:111], v[132:135], v[8:11], v[96:111]
  ds_read_b128 v[60:63], v39 offset:48128
  s_waitcnt lgkmcnt(8)
  v_mfma_f32_32x32x16_bf16 v[112:127], v[132:135], v[12:15], v[112:127]
  s_waitcnt lgkmcnt(7)
  v_mfma_f32_32x32x16_bf16 v[64:79], v[136:139], v[16:19], v[64:79]
  s_waitcnt vmcnt(0) lgkmcnt(0)
  s_barrier
  v_add_u32 v7, 65536, v7
  ds_read_b64_tr_b16 v[144:145], v7 offset:49152
  ds_read_b64_tr_b16 v[146:147], v7 offset:51200
  ds_read_b64_tr_b16 v[148:149], v7 offset:53248
  ds_read_b64_tr_b16 v[150:151], v7 offset:55296
  ds_read_b64_tr_b16 v[152:153], v7 offset:57344
  ds_read_b64_tr_b16 v[154:155], v7 offset:59392
  ds_read_b64_tr_b16 v[156:157], v7 offset:61440
  ds_read_b64_tr_b16 v[158:159], v7 offset:63488
  v_mfma_f32_32x32x16_bf16 v[80:95], v[136:139], v[20:23], v[80:95]
  v_add_u32 v39, 131072, v39
  ds_read_b128 v[8:11], v39 offset:0
  ds_read_b128 v[12:15], v39 offset:4096
  v_mfma_f32_32x32x16_bf16 v[96:111], v[136:139], v[40:43], v[96:111]
  ds_read_b128 v[16:19], v39 offset:8192
  ds_read_b128 v[20:23], v39 offset:12288
  v_mfma_f32_32x32x16_bf16 v[112:127], v[136:139], v[44:47], v[112:127]
  ds_read_b128 v[40:43], v39 offset:1024
  v_mfma_f32_32x32x16_bf16 v[64:79], v[140:143], v[48:51], v[64:79]
  ds_read_b128 v[44:47], v39 offset:5120
  v_mfma_f32_32x32x16_bf16 v[80:95], v[140:143], v[52:55], v[80:95]
  ds_read_b128 v[48:51], v39 offset:9216
  v_mfma_f32_32x32x16_bf16 v[96:111], v[140:143], v[56:59], v[96:111]
  ds_read_b128 v[52:55], v39 offset:13312
  v_mfma_f32_32x32x16_bf16 v[112:127], v[140:143], v[60:63], v[112:127]
  ds_read_b128 v[56:59], v39 offset:2048
  s_waitcnt lgkmcnt(8)
  v_mfma_f32_32x32x16_bf16 v[64:79], v[144:147], v[8:11], v[64:79]
  ds_read_b128 v[60:63], v39 offset:6144
  s_waitcnt lgkmcnt(8)
  v_mfma_f32_32x32x16_bf16 v[80:95], v[144:147], v[12:15], v[80:95]
  ds_read_b128 v[8:11], v39 offset:10240
  s_waitcnt lgkmcnt(8)
  v_mfma_f32_32x32x16_bf16 v[96:111], v[144:147], v[16:19], v[96:111]
  ds_read_b128 v[12:15], v39 offset:14336
  s_waitcnt lgkmcnt(8)
  v_mfma_f32_32x32x16_bf16 v[112:127], v[144:147], v[20:23], v[112:127]
  ds_read_b128 v[16:19], v39 offset:3072
  s_waitcnt lgkmcnt(8)
  v_mfma_f32_32x32x16_bf16 v[64:79], v[148:151], v[40:43], v[64:79]
  ds_read_b128 v[20:23], v39 offset:7168
  s_waitcnt lgkmcnt(8)
  v_mfma_f32_32x32x16_bf16 v[80:95], v[148:151], v[44:47], v[80:95]
  ds_read_b128 v[40:43], v39 offset:11264
  s_waitcnt lgkmcnt(8)
  v_mfma_f32_32x32x16_bf16 v[96:111], v[148:151], v[48:51], v[96:111]
  ds_read_b128 v[44:47], v39 offset:15360
  s_waitcnt lgkmcnt(8)
  v_mfma_f32_32x32x16_bf16 v[112:127], v[148:151], v[52:55], v[112:127]
  s_waitcnt lgkmcnt(7)
  v_mfma_f32_32x32x16_bf16 v[64:79], v[152:155], v[56:59], v[64:79]
  s_waitcnt vmcnt(9) lgkmcnt(0)
  s_barrier
  v_add_u32 v7, 65536, v7
  ds_read_b64_tr_b16 v[128:129], v7 offset:16384
  ds_read_b64_tr_b16 v[130:131], v7 offset:18432
  ds_read_b64_tr_b16 v[132:133], v7 offset:20480
  ds_read_b64_tr_b16 v[134:135], v7 offset:22528
  ds_read_b64_tr_b16 v[136:137], v7 offset:24576
  ds_read_b64_tr_b16 v[138:139], v7 offset:26624
  ds_read_b64_tr_b16 v[140:141], v7 offset:28672
  ds_read_b64_tr_b16 v[142:143], v7 offset:30720
  v_mfma_f32_32x32x16_bf16 v[80:95], v[152:155], v[60:63], v[80:95]
  v_subrev_u32 v39, 131072, v39
  ds_read_b128 v[48:51], v39 offset:49152
  ds_read_b128 v[52:55], v39 offset:53248
  v_mfma_f32_32x32x16_bf16 v[96:111], v[152:155], v[8:11], v[96:111]
  ds_read_b128 v[56:59], v39 offset:57344
  ds_read_b128 v[60:63], v39 offset:61440
  v_mfma_f32_32x32x16_bf16 v[112:127], v[152:155], v[12:15], v[112:127]
  ds_read_b128 v[8:11], v39 offset:50176
  v_mfma_f32_32x32x16_bf16 v[64:79], v[156:159], v[16:19], v[64:79]
  ds_read_b128 v[12:15], v39 offset:54272
  v_mfma_f32_32x32x16_bf16 v[80:95], v[156:159], v[20:23], v[80:95]
  ds_read_b128 v[16:19], v39 offset:58368
  v_mfma_f32_32x32x16_bf16 v[96:111], v[156:159], v[40:43], v[96:111]
  ds_read_b128 v[20:23], v39 offset:62464
  v_mfma_f32_32x32x16_bf16 v[112:127], v[156:159], v[44:47], v[112:127]
  ds_read_b128 v[40:43], v39 offset:51200
  s_waitcnt lgkmcnt(8)
  v_mfma_f32_32x32x16_bf16 v[64:79], v[128:131], v[48:51], v[64:79]
  ds_read_b128 v[44:47], v39 offset:55296
  s_waitcnt lgkmcnt(8)
  v_mfma_f32_32x32x16_bf16 v[80:95], v[128:131], v[52:55], v[80:95]
  ds_read_b128 v[48:51], v39 offset:59392
  s_waitcnt lgkmcnt(8)
  v_mfma_f32_32x32x16_bf16 v[96:111], v[128:131], v[56:59], v[96:111]
  ds_read_b128 v[52:55], v39 offset:63488
  s_waitcnt lgkmcnt(8)
  v_mfma_f32_32x32x16_bf16 v[112:127], v[128:131], v[60:63], v[112:127]
  ds_read_b128 v[56:59], v39 offset:52224
  s_waitcnt lgkmcnt(8)
  v_mfma_f32_32x32x16_bf16 v[64:79], v[132:135], v[8:11], v[64:79]
  ds_read_b128 v[60:63], v39 offset:56320
  s_waitcnt lgkmcnt(8)
  v_mfma_f32_32x32x16_bf16 v[80:95], v[132:135], v[12:15], v[80:95]
  ds_read_b128 v[8:11], v39 offset:60416
  s_waitcnt lgkmcnt(8)
  v_mfma_f32_32x32x16_bf16 v[96:111], v[132:135], v[16:19], v[96:111]
  ds_read_b128 v[12:15], v39 offset:64512
  s_waitcnt lgkmcnt(8)
  v_mfma_f32_32x32x16_bf16 v[112:127], v[132:135], v[20:23], v[112:127]
  s_waitcnt lgkmcnt(7)
  v_mfma_f32_32x32x16_bf16 v[64:79], v[136:139], v[40:43], v[64:79]
  s_waitcnt lgkmcnt(0)
  s_barrier
  v_subrev_u32 v7, 65536, v7
  ds_read_b64_tr_b16 v[144:145], v7 offset:0
  ds_read_b64_tr_b16 v[146:147], v7 offset:2048
  ds_read_b64_tr_b16 v[148:149], v7 offset:4096
  ds_read_b64_tr_b16 v[150:151], v7 offset:6144
  ds_read_b64_tr_b16 v[152:153], v7 offset:8192
  ds_read_b64_tr_b16 v[154:155], v7 offset:10240
  ds_read_b64_tr_b16 v[156:157], v7 offset:12288
  ds_read_b64_tr_b16 v[158:159], v7 offset:14336
  v_mfma_f32_32x32x16_bf16 v[80:95], v[136:139], v[44:47], v[80:95]
  v_add_u32 v39, 65536, v39
  ds_read_b128 v[16:19], v39 offset:16384
  ds_read_b128 v[20:23], v39 offset:20480
  v_mfma_f32_32x32x16_bf16 v[96:111], v[136:139], v[48:51], v[96:111]
  ds_read_b128 v[40:43], v39 offset:24576
  ds_read_b128 v[44:47], v39 offset:28672
  v_mfma_f32_32x32x16_bf16 v[112:127], v[136:139], v[52:55], v[112:127]
  ds_read_b128 v[48:51], v39 offset:17408
  v_mfma_f32_32x32x16_bf16 v[64:79], v[140:143], v[56:59], v[64:79]
  ds_read_b128 v[52:55], v39 offset:21504
  v_mfma_f32_32x32x16_bf16 v[80:95], v[140:143], v[60:63], v[80:95]
  ds_read_b128 v[56:59], v39 offset:25600
  v_mfma_f32_32x32x16_bf16 v[96:111], v[140:143], v[8:11], v[96:111]
  ds_read_b128 v[60:63], v39 offset:29696
  v_mfma_f32_32x32x16_bf16 v[112:127], v[140:143], v[12:15], v[112:127]
  ds_read_b128 v[8:11], v39 offset:18432
  s_waitcnt lgkmcnt(8)
  v_mfma_f32_32x32x16_bf16 v[64:79], v[144:147], v[16:19], v[64:79]
  ds_read_b128 v[12:15], v39 offset:22528
  s_waitcnt lgkmcnt(8)
  v_mfma_f32_32x32x16_bf16 v[80:95], v[144:147], v[20:23], v[80:95]
  ds_read_b128 v[16:19], v39 offset:26624
  s_waitcnt lgkmcnt(8)
  v_mfma_f32_32x32x16_bf16 v[96:111], v[144:147], v[40:43], v[96:111]
  ds_read_b128 v[20:23], v39 offset:30720
  s_waitcnt lgkmcnt(8)
  v_mfma_f32_32x32x16_bf16 v[112:127], v[144:147], v[44:47], v[112:127]
  ds_read_b128 v[40:43], v39 offset:19456
  s_waitcnt lgkmcnt(8)
  v_mfma_f32_32x32x16_bf16 v[64:79], v[148:151], v[48:51], v[64:79]
  ds_read_b128 v[44:47], v39 offset:23552
  s_waitcnt lgkmcnt(8)
  v_mfma_f32_32x32x16_bf16 v[80:95], v[148:151], v[52:55], v[80:95]
  ds_read_b128 v[48:51], v39 offset:27648
  s_waitcnt lgkmcnt(8)
  v_mfma_f32_32x32x16_bf16 v[96:111], v[148:151], v[56:59], v[96:111]
  ds_read_b128 v[52:55], v39 offset:31744
  s_waitcnt lgkmcnt(8)
  v_mfma_f32_32x32x16_bf16 v[112:127], v[148:151], v[60:63], v[112:127]
  s_waitcnt lgkmcnt(7)
  v_mfma_f32_32x32x16_bf16 v[64:79], v[152:155], v[8:11], v[64:79]
  s_waitcnt lgkmcnt(0)
  s_barrier
  v_subrev_u32 v7, 65536, v7
  ds_read_b64_tr_b16 v[128:129], v7 offset:0
  ds_read_b64_tr_b16 v[130:131], v7 offset:2048
  ds_read_b64_tr_b16 v[132:133], v7 offset:4096
  ds_read_b64_tr_b16 v[134:135], v7 offset:6144
  ds_read_b64_tr_b16 v[136:137], v7 offset:8192
  ds_read_b64_tr_b16 v[138:139], v7 offset:10240
  ds_read_b64_tr_b16 v[140:141], v7 offset:12288
  ds_read_b64_tr_b16 v[142:143], v7 offset:14336
  v_mfma_f32_32x32x16_bf16 v[80:95], v[152:155], v[12:15], v[80:95]
  ds_read_b128 v[56:59], v39 offset:32768
  ds_read_b128 v[60:63], v39 offset:36864
  v_mfma_f32_32x32x16_bf16 v[96:111], v[152:155], v[16:19], v[96:111]
  ds_read_b128 v[8:11], v39 offset:40960
  ds_read_b128 v[12:15], v39 offset:45056
  v_mfma_f32_32x32x16_bf16 v[112:127], v[152:155], v[20:23], v[112:127]
  ds_read_b128 v[16:19], v39 offset:33792
  v_mfma_f32_32x32x16_bf16 v[64:79], v[156:159], v[40:43], v[64:79]
  ds_read_b128 v[20:23], v39 offset:37888
  v_mfma_f32_32x32x16_bf16 v[80:95], v[156:159], v[44:47], v[80:95]
  ds_read_b128 v[40:43], v39 offset:41984
  v_mfma_f32_32x32x16_bf16 v[96:111], v[156:159], v[48:51], v[96:111]
  ds_read_b128 v[44:47], v39 offset:46080
  v_mfma_f32_32x32x16_bf16 v[112:127], v[156:159], v[52:55], v[112:127]
  ds_read_b128 v[48:51], v39 offset:34816
  s_waitcnt lgkmcnt(8)
  v_mfma_f32_32x32x16_bf16 v[64:79], v[128:131], v[56:59], v[64:79]
  ds_read_b128 v[52:55], v39 offset:38912
  s_waitcnt lgkmcnt(8)
  v_mfma_f32_32x32x16_bf16 v[80:95], v[128:131], v[60:63], v[80:95]
  ds_read_b128 v[56:59], v39 offset:43008
  s_waitcnt lgkmcnt(8)
  v_mfma_f32_32x32x16_bf16 v[96:111], v[128:131], v[8:11], v[96:111]
  ds_read_b128 v[60:63], v39 offset:47104
  s_waitcnt lgkmcnt(8)
  v_mfma_f32_32x32x16_bf16 v[112:127], v[128:131], v[12:15], v[112:127]
  ds_read_b128 v[8:11], v39 offset:35840
  s_waitcnt lgkmcnt(8)
  v_mfma_f32_32x32x16_bf16 v[64:79], v[132:135], v[16:19], v[64:79]
  ds_read_b128 v[12:15], v39 offset:39936
  s_waitcnt lgkmcnt(8)
  v_mfma_f32_32x32x16_bf16 v[80:95], v[132:135], v[20:23], v[80:95]
  ds_read_b128 v[16:19], v39 offset:44032
  s_waitcnt lgkmcnt(8)
  v_mfma_f32_32x32x16_bf16 v[96:111], v[132:135], v[40:43], v[96:111]
  ds_read_b128 v[20:23], v39 offset:48128
  s_waitcnt lgkmcnt(8)
  v_mfma_f32_32x32x16_bf16 v[112:127], v[132:135], v[44:47], v[112:127]
  s_waitcnt lgkmcnt(7)
  v_mfma_f32_32x32x16_bf16 v[64:79], v[136:139], v[48:51], v[64:79]
  s_waitcnt lgkmcnt(0)
  s_barrier
  ds_read_b64_tr_b16 v[144:145], v7 offset:16384
  ds_read_b64_tr_b16 v[146:147], v7 offset:18432
  ds_read_b64_tr_b16 v[148:149], v7 offset:20480
  ds_read_b64_tr_b16 v[150:151], v7 offset:22528
  ds_read_b64_tr_b16 v[152:153], v7 offset:24576
  ds_read_b64_tr_b16 v[154:155], v7 offset:26624
  ds_read_b64_tr_b16 v[156:157], v7 offset:28672
  ds_read_b64_tr_b16 v[158:159], v7 offset:30720
  v_mfma_f32_32x32x16_bf16 v[80:95], v[136:139], v[52:55], v[80:95]
  v_subrev_u32 v39, 65536, v39
  ds_read_b128 v[40:43], v39 offset:32768
  ds_read_b128 v[44:47], v39 offset:36864
  v_mfma_f32_32x32x16_bf16 v[96:111], v[136:139], v[56:59], v[96:111]
  ds_read_b128 v[48:51], v39 offset:40960
  ds_read_b128 v[52:55], v39 offset:45056
  v_mfma_f32_32x32x16_bf16 v[112:127], v[136:139], v[60:63], v[112:127]
  ds_read_b128 v[56:59], v39 offset:33792
  v_mfma_f32_32x32x16_bf16 v[64:79], v[140:143], v[8:11], v[64:79]
  ds_read_b128 v[60:63], v39 offset:37888
  v_mfma_f32_32x32x16_bf16 v[80:95], v[140:143], v[12:15], v[80:95]
  ds_read_b128 v[8:11], v39 offset:41984
  v_mfma_f32_32x32x16_bf16 v[96:111], v[140:143], v[16:19], v[96:111]
  ds_read_b128 v[12:15], v39 offset:46080
  v_mfma_f32_32x32x16_bf16 v[112:127], v[140:143], v[20:23], v[112:127]
  ds_read_b128 v[16:19], v39 offset:34816
  s_waitcnt lgkmcnt(8)
  v_mfma_f32_32x32x16_bf16 v[64:79], v[144:147], v[40:43], v[64:79]
  ds_read_b128 v[20:23], v39 offset:38912
  s_waitcnt lgkmcnt(8)
  v_mfma_f32_32x32x16_bf16 v[80:95], v[144:147], v[44:47], v[80:95]
  ds_read_b128 v[40:43], v39 offset:43008
  s_waitcnt lgkmcnt(8)
  v_mfma_f32_32x32x16_bf16 v[96:111], v[144:147], v[48:51], v[96:111]
  ds_read_b128 v[44:47], v39 offset:47104
  s_waitcnt lgkmcnt(8)
  v_mfma_f32_32x32x16_bf16 v[112:127], v[144:147], v[52:55], v[112:127]
  ds_read_b128 v[48:51], v39 offset:35840
  s_waitcnt lgkmcnt(8)
  v_mfma_f32_32x32x16_bf16 v[64:79], v[148:151], v[56:59], v[64:79]
  ds_read_b128 v[52:55], v39 offset:39936
  s_waitcnt lgkmcnt(8)
  v_mfma_f32_32x32x16_bf16 v[80:95], v[148:151], v[60:63], v[80:95]
  ds_read_b128 v[56:59], v39 offset:44032
  s_waitcnt lgkmcnt(8)
  v_mfma_f32_32x32x16_bf16 v[96:111], v[148:151], v[8:11], v[96:111]
  ds_read_b128 v[60:63], v39 offset:48128
  s_waitcnt lgkmcnt(8)
  v_mfma_f32_32x32x16_bf16 v[112:127], v[148:151], v[12:15], v[112:127]
  s_waitcnt lgkmcnt(7)
  v_mfma_f32_32x32x16_bf16 v[64:79], v[152:155], v[16:19], v[64:79]
  s_waitcnt lgkmcnt(0)
  s_barrier
  v_add_u32 v7, 65536, v7
  ds_read_b64_tr_b16 v[128:129], v7 offset:49152
  ds_read_b64_tr_b16 v[130:131], v7 offset:51200
  ds_read_b64_tr_b16 v[132:133], v7 offset:53248
  ds_read_b64_tr_b16 v[134:135], v7 offset:55296
  ds_read_b64_tr_b16 v[136:137], v7 offset:57344
  ds_read_b64_tr_b16 v[138:139], v7 offset:59392
  ds_read_b64_tr_b16 v[140:141], v7 offset:61440
  ds_read_b64_tr_b16 v[142:143], v7 offset:63488
  v_mfma_f32_32x32x16_bf16 v[80:95], v[152:155], v[20:23], v[80:95]
  v_add_u32 v39, 131072, v39
  ds_read_b128 v[8:11], v39 offset:0
  ds_read_b128 v[12:15], v39 offset:4096
  v_mfma_f32_32x32x16_bf16 v[96:111], v[152:155], v[40:43], v[96:111]
  ds_read_b128 v[16:19], v39 offset:8192
  ds_read_b128 v[20:23], v39 offset:12288
  v_mfma_f32_32x32x16_bf16 v[112:127], v[152:155], v[44:47], v[112:127]
  ds_read_b128 v[40:43], v39 offset:1024
  v_mfma_f32_32x32x16_bf16 v[64:79], v[156:159], v[48:51], v[64:79]
  ds_read_b128 v[44:47], v39 offset:5120
  v_mfma_f32_32x32x16_bf16 v[80:95], v[156:159], v[52:55], v[80:95]
  ds_read_b128 v[48:51], v39 offset:9216
  v_mfma_f32_32x32x16_bf16 v[96:111], v[156:159], v[56:59], v[96:111]
  ds_read_b128 v[52:55], v39 offset:13312
  v_mfma_f32_32x32x16_bf16 v[112:127], v[156:159], v[60:63], v[112:127]
  ds_read_b128 v[56:59], v39 offset:2048
  s_waitcnt lgkmcnt(8)
  v_mfma_f32_32x32x16_bf16 v[64:79], v[128:131], v[8:11], v[64:79]
  ds_read_b128 v[60:63], v39 offset:6144
  s_waitcnt lgkmcnt(8)
  v_mfma_f32_32x32x16_bf16 v[80:95], v[128:131], v[12:15], v[80:95]
  ds_read_b128 v[8:11], v39 offset:10240
  s_waitcnt lgkmcnt(8)
  v_mfma_f32_32x32x16_bf16 v[96:111], v[128:131], v[16:19], v[96:111]
  ds_read_b128 v[12:15], v39 offset:14336
  s_waitcnt lgkmcnt(8)
  v_mfma_f32_32x32x16_bf16 v[112:127], v[128:131], v[20:23], v[112:127]
  ds_read_b128 v[16:19], v39 offset:3072
  s_waitcnt lgkmcnt(8)
  v_mfma_f32_32x32x16_bf16 v[64:79], v[132:135], v[40:43], v[64:79]
  ds_read_b128 v[20:23], v39 offset:7168
  s_waitcnt lgkmcnt(8)
  v_mfma_f32_32x32x16_bf16 v[80:95], v[132:135], v[44:47], v[80:95]
  ds_read_b128 v[40:43], v39 offset:11264
  s_waitcnt lgkmcnt(8)
  v_mfma_f32_32x32x16_bf16 v[96:111], v[132:135], v[48:51], v[96:111]
  ds_read_b128 v[44:47], v39 offset:15360
  s_waitcnt lgkmcnt(8)
  v_mfma_f32_32x32x16_bf16 v[112:127], v[132:135], v[52:55], v[112:127]
  s_waitcnt lgkmcnt(7)
  v_mfma_f32_32x32x16_bf16 v[64:79], v[136:139], v[56:59], v[64:79]
  s_waitcnt lgkmcnt(0)
  s_barrier
  v_subrev_u32 v7, 65536, v7
  ds_read_b64_tr_b16 v[144:145], v7 offset:49152
  ds_read_b64_tr_b16 v[146:147], v7 offset:51200
  ds_read_b64_tr_b16 v[148:149], v7 offset:53248
  ds_read_b64_tr_b16 v[150:151], v7 offset:55296
  ds_read_b64_tr_b16 v[152:153], v7 offset:57344
  ds_read_b64_tr_b16 v[154:155], v7 offset:59392
  ds_read_b64_tr_b16 v[156:157], v7 offset:61440
  ds_read_b64_tr_b16 v[158:159], v7 offset:63488
  v_mfma_f32_32x32x16_bf16 v[80:95], v[136:139], v[60:63], v[80:95]
  ds_read_b128 v[48:51], v39 offset:16384
  ds_read_b128 v[52:55], v39 offset:20480
  v_mfma_f32_32x32x16_bf16 v[96:111], v[136:139], v[8:11], v[96:111]
  ds_read_b128 v[56:59], v39 offset:24576
  ds_read_b128 v[60:63], v39 offset:28672
  v_mfma_f32_32x32x16_bf16 v[112:127], v[136:139], v[12:15], v[112:127]
  ds_read_b128 v[8:11], v39 offset:17408
  v_mfma_f32_32x32x16_bf16 v[64:79], v[140:143], v[16:19], v[64:79]
  ds_read_b128 v[12:15], v39 offset:21504
  v_mfma_f32_32x32x16_bf16 v[80:95], v[140:143], v[20:23], v[80:95]
  ds_read_b128 v[16:19], v39 offset:25600
  v_mfma_f32_32x32x16_bf16 v[96:111], v[140:143], v[40:43], v[96:111]
  ds_read_b128 v[20:23], v39 offset:29696
  v_mfma_f32_32x32x16_bf16 v[112:127], v[140:143], v[44:47], v[112:127]
  ds_read_b128 v[40:43], v39 offset:18432
  s_waitcnt lgkmcnt(8)
  v_mfma_f32_32x32x16_bf16 v[64:79], v[144:147], v[48:51], v[64:79]
  ds_read_b128 v[44:47], v39 offset:22528
  s_waitcnt lgkmcnt(8)
  v_mfma_f32_32x32x16_bf16 v[80:95], v[144:147], v[52:55], v[80:95]
  ds_read_b128 v[48:51], v39 offset:26624
  s_waitcnt lgkmcnt(8)
  v_mfma_f32_32x32x16_bf16 v[96:111], v[144:147], v[56:59], v[96:111]
  ds_read_b128 v[52:55], v39 offset:30720
  s_waitcnt lgkmcnt(8)
  v_mfma_f32_32x32x16_bf16 v[112:127], v[144:147], v[60:63], v[112:127]
  ds_read_b128 v[56:59], v39 offset:19456
  s_waitcnt lgkmcnt(8)
  v_mfma_f32_32x32x16_bf16 v[64:79], v[148:151], v[8:11], v[64:79]
  ds_read_b128 v[60:63], v39 offset:23552
  s_waitcnt lgkmcnt(8)
  v_mfma_f32_32x32x16_bf16 v[80:95], v[148:151], v[12:15], v[80:95]
  ds_read_b128 v[8:11], v39 offset:27648
  s_waitcnt lgkmcnt(8)
  v_mfma_f32_32x32x16_bf16 v[96:111], v[148:151], v[16:19], v[96:111]
  ds_read_b128 v[12:15], v39 offset:31744
  s_waitcnt lgkmcnt(8)
  v_mfma_f32_32x32x16_bf16 v[112:127], v[148:151], v[20:23], v[112:127]
  s_waitcnt lgkmcnt(7)
  v_mfma_f32_32x32x16_bf16 v[64:79], v[152:155], v[40:43], v[64:79]
  s_waitcnt lgkmcnt(0)
  s_barrier
  v_add_u32 v7, 65536, v7
  ds_read_b64_tr_b16 v[128:129], v7 offset:0
  ds_read_b64_tr_b16 v[130:131], v7 offset:2048
  ds_read_b64_tr_b16 v[132:133], v7 offset:4096
  ds_read_b64_tr_b16 v[134:135], v7 offset:6144
  ds_read_b64_tr_b16 v[136:137], v7 offset:8192
  ds_read_b64_tr_b16 v[138:139], v7 offset:10240
  ds_read_b64_tr_b16 v[140:141], v7 offset:12288
  ds_read_b64_tr_b16 v[142:143], v7 offset:14336
  v_mfma_f32_32x32x16_bf16 v[80:95], v[152:155], v[44:47], v[80:95]
  v_subrev_u32 v39, 65536, v39
  ds_read_b128 v[16:19], v39 offset:16384
  ds_read_b128 v[20:23], v39 offset:20480
  v_mfma_f32_32x32x16_bf16 v[96:111], v[152:155], v[48:51], v[96:111]
  ds_read_b128 v[40:43], v39 offset:24576
  ds_read_b128 v[44:47], v39 offset:28672
  v_mfma_f32_32x32x16_bf16 v[112:127], v[152:155], v[52:55], v[112:127]
  ds_read_b128 v[48:51], v39 offset:17408
  v_mfma_f32_32x32x16_bf16 v[64:79], v[156:159], v[56:59], v[64:79]
  ds_read_b128 v[52:55], v39 offset:21504
  v_mfma_f32_32x32x16_bf16 v[80:95], v[156:159], v[60:63], v[80:95]
  ds_read_b128 v[56:59], v39 offset:25600
  v_mfma_f32_32x32x16_bf16 v[96:111], v[156:159], v[8:11], v[96:111]
  ds_read_b128 v[60:63], v39 offset:29696
  v_mfma_f32_32x32x16_bf16 v[112:127], v[156:159], v[12:15], v[112:127]
  ds_read_b128 v[8:11], v39 offset:18432
  s_waitcnt lgkmcnt(8)
  v_mfma_f32_32x32x16_bf16 v[64:79], v[128:131], v[16:19], v[64:79]
  ds_read_b128 v[12:15], v39 offset:22528
  s_waitcnt lgkmcnt(8)
  v_mfma_f32_32x32x16_bf16 v[80:95], v[128:131], v[20:23], v[80:95]
  ds_read_b128 v[16:19], v39 offset:26624
  s_waitcnt lgkmcnt(8)
  v_mfma_f32_32x32x16_bf16 v[96:111], v[128:131], v[40:43], v[96:111]
  ds_read_b128 v[20:23], v39 offset:30720
  s_waitcnt lgkmcnt(8)
  v_mfma_f32_32x32x16_bf16 v[112:127], v[128:131], v[44:47], v[112:127]
  ds_read_b128 v[40:43], v39 offset:19456
  s_waitcnt lgkmcnt(8)
  v_mfma_f32_32x32x16_bf16 v[64:79], v[132:135], v[48:51], v[64:79]
  ds_read_b128 v[44:47], v39 offset:23552
  s_waitcnt lgkmcnt(8)
  v_mfma_f32_32x32x16_bf16 v[80:95], v[132:135], v[52:55], v[80:95]
  ds_read_b128 v[48:51], v39 offset:27648
  s_waitcnt lgkmcnt(8)
  v_mfma_f32_32x32x16_bf16 v[96:111], v[132:135], v[56:59], v[96:111]
  ds_read_b128 v[52:55], v39 offset:31744
  s_waitcnt lgkmcnt(8)
  v_mfma_f32_32x32x16_bf16 v[112:127], v[132:135], v[60:63], v[112:127]
  s_waitcnt lgkmcnt(7)
  v_mfma_f32_32x32x16_bf16 v[64:79], v[136:139], v[8:11], v[64:79]
  s_waitcnt lgkmcnt(0)
  s_barrier
  v_subrev_u32 v7, 65536, v7
  ds_read_b64_tr_b16 v[144:145], v7 offset:0
  ds_read_b64_tr_b16 v[146:147], v7 offset:2048
  ds_read_b64_tr_b16 v[148:149], v7 offset:4096
  ds_read_b64_tr_b16 v[150:151], v7 offset:6144
  ds_read_b64_tr_b16 v[152:153], v7 offset:8192
  ds_read_b64_tr_b16 v[154:155], v7 offset:10240
  ds_read_b64_tr_b16 v[156:157], v7 offset:12288
  ds_read_b64_tr_b16 v[158:159], v7 offset:14336
  v_mfma_f32_32x32x16_bf16 v[80:95], v[136:139], v[12:15], v[80:95]
  ds_read_b128 v[56:59], v39 offset:32768
  ds_read_b128 v[60:63], v39 offset:36864
  v_mfma_f32_32x32x16_bf16 v[96:111], v[136:139], v[16:19], v[96:111]
  ds_read_b128 v[8:11], v39 offset:40960
  ds_read_b128 v[12:15], v39 offset:45056
  v_mfma_f32_32x32x16_bf16 v[112:127], v[136:139], v[20:23], v[112:127]
  ds_read_b128 v[16:19], v39 offset:33792
  v_mfma_f32_32x32x16_bf16 v[64:79], v[140:143], v[40:43], v[64:79]
  ds_read_b128 v[20:23], v39 offset:37888
  v_mfma_f32_32x32x16_bf16 v[80:95], v[140:143], v[44:47], v[80:95]
  ds_read_b128 v[40:43], v39 offset:41984
  v_mfma_f32_32x32x16_bf16 v[96:111], v[140:143], v[48:51], v[96:111]
  ds_read_b128 v[44:47], v39 offset:46080
  v_mfma_f32_32x32x16_bf16 v[112:127], v[140:143], v[52:55], v[112:127]
  ds_read_b128 v[48:51], v39 offset:34816
  s_waitcnt lgkmcnt(8)
  v_mfma_f32_32x32x16_bf16 v[64:79], v[144:147], v[56:59], v[64:79]
  ds_read_b128 v[52:55], v39 offset:38912
  s_waitcnt lgkmcnt(8)
  v_mfma_f32_32x32x16_bf16 v[80:95], v[144:147], v[60:63], v[80:95]
  ds_read_b128 v[56:59], v39 offset:43008
  s_waitcnt lgkmcnt(8)
  v_mfma_f32_32x32x16_bf16 v[96:111], v[144:147], v[8:11], v[96:111]
  ds_read_b128 v[60:63], v39 offset:47104
  s_waitcnt lgkmcnt(8)
  v_mfma_f32_32x32x16_bf16 v[112:127], v[144:147], v[12:15], v[112:127]
  ds_read_b128 v[8:11], v39 offset:35840
  s_waitcnt lgkmcnt(8)
  v_mfma_f32_32x32x16_bf16 v[64:79], v[148:151], v[16:19], v[64:79]
  ds_read_b128 v[12:15], v39 offset:39936
  s_waitcnt lgkmcnt(8)
  v_mfma_f32_32x32x16_bf16 v[80:95], v[148:151], v[20:23], v[80:95]
  ds_read_b128 v[16:19], v39 offset:44032
  s_waitcnt lgkmcnt(8)
  v_mfma_f32_32x32x16_bf16 v[96:111], v[148:151], v[40:43], v[96:111]
  ds_read_b128 v[20:23], v39 offset:48128
  s_waitcnt lgkmcnt(8)
  v_mfma_f32_32x32x16_bf16 v[112:127], v[148:151], v[44:47], v[112:127]
  s_waitcnt lgkmcnt(7)
  v_mfma_f32_32x32x16_bf16 v[64:79], v[152:155], v[48:51], v[64:79]
  s_waitcnt lgkmcnt(0)
  s_barrier
  ds_read_b64_tr_b16 v[128:129], v7 offset:16384
  ds_read_b64_tr_b16 v[130:131], v7 offset:18432
  ds_read_b64_tr_b16 v[132:133], v7 offset:20480
  ds_read_b64_tr_b16 v[134:135], v7 offset:22528
  ds_read_b64_tr_b16 v[136:137], v7 offset:24576
  ds_read_b64_tr_b16 v[138:139], v7 offset:26624
  ds_read_b64_tr_b16 v[140:141], v7 offset:28672
  ds_read_b64_tr_b16 v[142:143], v7 offset:30720
  v_mfma_f32_32x32x16_bf16 v[80:95], v[152:155], v[52:55], v[80:95]
  v_subrev_u32 v39, 65536, v39
  ds_read_b128 v[40:43], v39 offset:32768
  ds_read_b128 v[44:47], v39 offset:36864
  v_mfma_f32_32x32x16_bf16 v[96:111], v[152:155], v[56:59], v[96:111]
  ds_read_b128 v[48:51], v39 offset:40960
  ds_read_b128 v[52:55], v39 offset:45056
  v_mfma_f32_32x32x16_bf16 v[112:127], v[152:155], v[60:63], v[112:127]
  ds_read_b128 v[56:59], v39 offset:33792
  v_mfma_f32_32x32x16_bf16 v[64:79], v[156:159], v[8:11], v[64:79]
  ds_read_b128 v[60:63], v39 offset:37888
  v_mfma_f32_32x32x16_bf16 v[80:95], v[156:159], v[12:15], v[80:95]
  ds_read_b128 v[8:11], v39 offset:41984
  v_mfma_f32_32x32x16_bf16 v[96:111], v[156:159], v[16:19], v[96:111]
  ds_read_b128 v[12:15], v39 offset:46080
  v_mfma_f32_32x32x16_bf16 v[112:127], v[156:159], v[20:23], v[112:127]
  ds_read_b128 v[16:19], v39 offset:34816
  s_waitcnt lgkmcnt(8)
  v_mfma_f32_32x32x16_bf16 v[64:79], v[128:131], v[40:43], v[64:79]
  ds_read_b128 v[20:23], v39 offset:38912
  s_waitcnt lgkmcnt(8)
  v_mfma_f32_32x32x16_bf16 v[80:95], v[128:131], v[44:47], v[80:95]
  ds_read_b128 v[40:43], v39 offset:43008
  s_waitcnt lgkmcnt(8)
  v_mfma_f32_32x32x16_bf16 v[96:111], v[128:131], v[48:51], v[96:111]
  ds_read_b128 v[44:47], v39 offset:47104
  s_waitcnt lgkmcnt(8)
  v_mfma_f32_32x32x16_bf16 v[112:127], v[128:131], v[52:55], v[112:127]
  ds_read_b128 v[48:51], v39 offset:35840
  s_waitcnt lgkmcnt(8)
  v_mfma_f32_32x32x16_bf16 v[64:79], v[132:135], v[56:59], v[64:79]
  ds_read_b128 v[52:55], v39 offset:39936
  s_waitcnt lgkmcnt(8)
  v_mfma_f32_32x32x16_bf16 v[80:95], v[132:135], v[60:63], v[80:95]
  ds_read_b128 v[56:59], v39 offset:44032
  s_waitcnt lgkmcnt(8)
  v_mfma_f32_32x32x16_bf16 v[96:111], v[132:135], v[8:11], v[96:111]
  ds_read_b128 v[60:63], v39 offset:48128
  s_waitcnt lgkmcnt(8)
  v_mfma_f32_32x32x16_bf16 v[112:127], v[132:135], v[12:15], v[112:127]
  s_waitcnt lgkmcnt(7)
  v_mfma_f32_32x32x16_bf16 v[64:79], v[136:139], v[16:19], v[64:79]
  s_waitcnt lgkmcnt(0)
  s_barrier
  v_add_u32 v7, 65536, v7
  ds_read_b64_tr_b16 v[144:145], v7 offset:49152
  ds_read_b64_tr_b16 v[146:147], v7 offset:51200
  ds_read_b64_tr_b16 v[148:149], v7 offset:53248
  ds_read_b64_tr_b16 v[150:151], v7 offset:55296
  ds_read_b64_tr_b16 v[152:153], v7 offset:57344
  ds_read_b64_tr_b16 v[154:155], v7 offset:59392
  ds_read_b64_tr_b16 v[156:157], v7 offset:61440
  ds_read_b64_tr_b16 v[158:159], v7 offset:63488
  v_mfma_f32_32x32x16_bf16 v[80:95], v[136:139], v[20:23], v[80:95]
  v_add_u32 v39, 131072, v39
  ds_read_b128 v[8:11], v39 offset:0
  ds_read_b128 v[12:15], v39 offset:4096
  v_mfma_f32_32x32x16_bf16 v[96:111], v[136:139], v[40:43], v[96:111]
  ds_read_b128 v[16:19], v39 offset:8192
  ds_read_b128 v[20:23], v39 offset:12288
  v_mfma_f32_32x32x16_bf16 v[112:127], v[136:139], v[44:47], v[112:127]
  ds_read_b128 v[40:43], v39 offset:1024
  v_mfma_f32_32x32x16_bf16 v[64:79], v[140:143], v[48:51], v[64:79]
  ds_read_b128 v[44:47], v39 offset:5120
  v_mfma_f32_32x32x16_bf16 v[80:95], v[140:143], v[52:55], v[80:95]
  ds_read_b128 v[48:51], v39 offset:9216
  v_mfma_f32_32x32x16_bf16 v[96:111], v[140:143], v[56:59], v[96:111]
  ds_read_b128 v[52:55], v39 offset:13312
  v_mfma_f32_32x32x16_bf16 v[112:127], v[140:143], v[60:63], v[112:127]
  ds_read_b128 v[56:59], v39 offset:2048
  s_waitcnt lgkmcnt(8)
  v_mfma_f32_32x32x16_bf16 v[64:79], v[144:147], v[8:11], v[64:79]
  ds_read_b128 v[60:63], v39 offset:6144
  s_waitcnt lgkmcnt(8)
  v_mfma_f32_32x32x16_bf16 v[80:95], v[144:147], v[12:15], v[80:95]
  ds_read_b128 v[8:11], v39 offset:10240
  s_waitcnt lgkmcnt(8)
  v_mfma_f32_32x32x16_bf16 v[96:111], v[144:147], v[16:19], v[96:111]
  ds_read_b128 v[12:15], v39 offset:14336
  s_waitcnt lgkmcnt(8)
  v_mfma_f32_32x32x16_bf16 v[112:127], v[144:147], v[20:23], v[112:127]
  ds_read_b128 v[16:19], v39 offset:3072
  s_waitcnt lgkmcnt(8)
  v_mfma_f32_32x32x16_bf16 v[64:79], v[148:151], v[40:43], v[64:79]
  ds_read_b128 v[20:23], v39 offset:7168
  s_waitcnt lgkmcnt(8)
  v_mfma_f32_32x32x16_bf16 v[80:95], v[148:151], v[44:47], v[80:95]
  ds_read_b128 v[40:43], v39 offset:11264
  s_waitcnt lgkmcnt(8)
  v_mfma_f32_32x32x16_bf16 v[96:111], v[148:151], v[48:51], v[96:111]
  ds_read_b128 v[44:47], v39 offset:15360
  s_waitcnt lgkmcnt(8)
  v_mfma_f32_32x32x16_bf16 v[112:127], v[148:151], v[52:55], v[112:127]
  s_waitcnt lgkmcnt(7)
  v_mfma_f32_32x32x16_bf16 v[64:79], v[152:155], v[56:59], v[64:79]
  s_waitcnt lgkmcnt(0)
  s_barrier
  v_subrev_u32 v7, 65536, v7
  ds_read_b64_tr_b16 v[128:129], v7 offset:49152
  ds_read_b64_tr_b16 v[130:131], v7 offset:51200
  ds_read_b64_tr_b16 v[132:133], v7 offset:53248
  ds_read_b64_tr_b16 v[134:135], v7 offset:55296
  ds_read_b64_tr_b16 v[136:137], v7 offset:57344
  ds_read_b64_tr_b16 v[138:139], v7 offset:59392
  ds_read_b64_tr_b16 v[140:141], v7 offset:61440
  ds_read_b64_tr_b16 v[142:143], v7 offset:63488
  v_mfma_f32_32x32x16_bf16 v[80:95], v[152:155], v[60:63], v[80:95]
  ds_read_b128 v[48:51], v39 offset:16384
  ds_read_b128 v[52:55], v39 offset:20480
  v_mfma_f32_32x32x16_bf16 v[96:111], v[152:155], v[8:11], v[96:111]
  ds_read_b128 v[56:59], v39 offset:24576
  ds_read_b128 v[60:63], v39 offset:28672
  v_mfma_f32_32x32x16_bf16 v[112:127], v[152:155], v[12:15], v[112:127]
  ds_read_b128 v[8:11], v39 offset:17408
  v_mfma_f32_32x32x16_bf16 v[64:79], v[156:159], v[16:19], v[64:79]
  ds_read_b128 v[12:15], v39 offset:21504
  v_mfma_f32_32x32x16_bf16 v[80:95], v[156:159], v[20:23], v[80:95]
  ds_read_b128 v[16:19], v39 offset:25600
  v_mfma_f32_32x32x16_bf16 v[96:111], v[156:159], v[40:43], v[96:111]
  ds_read_b128 v[20:23], v39 offset:29696
  v_mfma_f32_32x32x16_bf16 v[112:127], v[156:159], v[44:47], v[112:127]
  ds_read_b128 v[40:43], v39 offset:18432
  s_waitcnt lgkmcnt(8)
  v_mfma_f32_32x32x16_bf16 v[64:79], v[128:131], v[48:51], v[64:79]
  ds_read_b128 v[44:47], v39 offset:22528
  s_waitcnt lgkmcnt(8)
  v_mfma_f32_32x32x16_bf16 v[80:95], v[128:131], v[52:55], v[80:95]
  ds_read_b128 v[48:51], v39 offset:26624
  s_waitcnt lgkmcnt(8)
  v_mfma_f32_32x32x16_bf16 v[96:111], v[128:131], v[56:59], v[96:111]
  ds_read_b128 v[52:55], v39 offset:30720
  s_waitcnt lgkmcnt(8)
  v_mfma_f32_32x32x16_bf16 v[112:127], v[128:131], v[60:63], v[112:127]
  ds_read_b128 v[56:59], v39 offset:19456
  s_waitcnt lgkmcnt(8)
  v_mfma_f32_32x32x16_bf16 v[64:79], v[132:135], v[8:11], v[64:79]
  ds_read_b128 v[60:63], v39 offset:23552
  s_waitcnt lgkmcnt(8)
  v_mfma_f32_32x32x16_bf16 v[80:95], v[132:135], v[12:15], v[80:95]
  ds_read_b128 v[8:11], v39 offset:27648
  s_waitcnt lgkmcnt(8)
  v_mfma_f32_32x32x16_bf16 v[96:111], v[132:135], v[16:19], v[96:111]
  ds_read_b128 v[12:15], v39 offset:31744
  s_waitcnt lgkmcnt(8)
  v_mfma_f32_32x32x16_bf16 v[112:127], v[132:135], v[20:23], v[112:127]
  s_waitcnt lgkmcnt(7)
  v_mfma_f32_32x32x16_bf16 v[64:79], v[136:139], v[40:43], v[64:79]
  s_waitcnt lgkmcnt(0)
  s_barrier
  v_add_u32 v7, 65536, v7
  ds_read_b64_tr_b16 v[144:145], v7 offset:0
  ds_read_b64_tr_b16 v[146:147], v7 offset:2048
  ds_read_b64_tr_b16 v[148:149], v7 offset:4096
  ds_read_b64_tr_b16 v[150:151], v7 offset:6144
  ds_read_b64_tr_b16 v[152:153], v7 offset:8192
  ds_read_b64_tr_b16 v[154:155], v7 offset:10240
  ds_read_b64_tr_b16 v[156:157], v7 offset:12288
  ds_read_b64_tr_b16 v[158:159], v7 offset:14336
  v_mfma_f32_32x32x16_bf16 v[80:95], v[136:139], v[44:47], v[80:95]
  v_subrev_u32 v39, 65536, v39
  ds_read_b128 v[16:19], v39 offset:16384
  ds_read_b128 v[20:23], v39 offset:20480
  v_mfma_f32_32x32x16_bf16 v[96:111], v[136:139], v[48:51], v[96:111]
  ds_read_b128 v[40:43], v39 offset:24576
  ds_read_b128 v[44:47], v39 offset:28672
  v_mfma_f32_32x32x16_bf16 v[112:127], v[136:139], v[52:55], v[112:127]
  ds_read_b128 v[48:51], v39 offset:17408
  v_mfma_f32_32x32x16_bf16 v[64:79], v[140:143], v[56:59], v[64:79]
  ds_read_b128 v[52:55], v39 offset:21504
  v_mfma_f32_32x32x16_bf16 v[80:95], v[140:143], v[60:63], v[80:95]
  ds_read_b128 v[56:59], v39 offset:25600
  v_mfma_f32_32x32x16_bf16 v[96:111], v[140:143], v[8:11], v[96:111]
  ds_read_b128 v[60:63], v39 offset:29696
  v_mfma_f32_32x32x16_bf16 v[112:127], v[140:143], v[12:15], v[112:127]
  ds_read_b128 v[8:11], v39 offset:18432
  s_waitcnt lgkmcnt(8)
  v_mfma_f32_32x32x16_bf16 v[64:79], v[144:147], v[16:19], v[64:79]
  ds_read_b128 v[12:15], v39 offset:22528
  s_waitcnt lgkmcnt(8)
  v_mfma_f32_32x32x16_bf16 v[80:95], v[144:147], v[20:23], v[80:95]
  ds_read_b128 v[16:19], v39 offset:26624
  s_waitcnt lgkmcnt(8)
  v_mfma_f32_32x32x16_bf16 v[96:111], v[144:147], v[40:43], v[96:111]
  ds_read_b128 v[20:23], v39 offset:30720
  s_waitcnt lgkmcnt(8)
  v_mfma_f32_32x32x16_bf16 v[112:127], v[144:147], v[44:47], v[112:127]
  ds_read_b128 v[40:43], v39 offset:19456
  s_waitcnt lgkmcnt(8)
  v_mfma_f32_32x32x16_bf16 v[64:79], v[148:151], v[48:51], v[64:79]
  ds_read_b128 v[44:47], v39 offset:23552
  s_waitcnt lgkmcnt(8)
  v_mfma_f32_32x32x16_bf16 v[80:95], v[148:151], v[52:55], v[80:95]
  ds_read_b128 v[48:51], v39 offset:27648
  s_waitcnt lgkmcnt(8)
  v_mfma_f32_32x32x16_bf16 v[96:111], v[148:151], v[56:59], v[96:111]
  ds_read_b128 v[52:55], v39 offset:31744
  s_waitcnt lgkmcnt(8)
  v_mfma_f32_32x32x16_bf16 v[112:127], v[148:151], v[60:63], v[112:127]
  s_waitcnt lgkmcnt(7)
  v_mfma_f32_32x32x16_bf16 v[64:79], v[152:155], v[8:11], v[64:79]
  s_waitcnt lgkmcnt(0)
  s_barrier
  v_subrev_u32 v7, 65536, v7
  ds_read_b64_tr_b16 v[128:129], v7 offset:0
  ds_read_b64_tr_b16 v[130:131], v7 offset:2048
  ds_read_b64_tr_b16 v[132:133], v7 offset:4096
  ds_read_b64_tr_b16 v[134:135], v7 offset:6144
  ds_read_b64_tr_b16 v[136:137], v7 offset:8192
  ds_read_b64_tr_b16 v[138:139], v7 offset:10240
  ds_read_b64_tr_b16 v[140:141], v7 offset:12288
  ds_read_b64_tr_b16 v[142:143], v7 offset:14336
  v_mfma_f32_32x32x16_bf16 v[80:95], v[152:155], v[12:15], v[80:95]
  ds_read_b128 v[56:59], v39 offset:32768
  ds_read_b128 v[60:63], v39 offset:36864
  v_mfma_f32_32x32x16_bf16 v[96:111], v[152:155], v[16:19], v[96:111]
  ds_read_b128 v[8:11], v39 offset:40960
  ds_read_b128 v[12:15], v39 offset:45056
  v_mfma_f32_32x32x16_bf16 v[112:127], v[152:155], v[20:23], v[112:127]
  ds_read_b128 v[16:19], v39 offset:33792
  v_mfma_f32_32x32x16_bf16 v[64:79], v[156:159], v[40:43], v[64:79]
  ds_read_b128 v[20:23], v39 offset:37888
  v_mfma_f32_32x32x16_bf16 v[80:95], v[156:159], v[44:47], v[80:95]
  ds_read_b128 v[40:43], v39 offset:41984
  v_mfma_f32_32x32x16_bf16 v[96:111], v[156:159], v[48:51], v[96:111]
  ds_read_b128 v[44:47], v39 offset:46080
  v_mfma_f32_32x32x16_bf16 v[112:127], v[156:159], v[52:55], v[112:127]
  ds_read_b128 v[48:51], v39 offset:34816
  s_waitcnt lgkmcnt(8)
  v_mfma_f32_32x32x16_bf16 v[64:79], v[128:131], v[56:59], v[64:79]
  ds_read_b128 v[52:55], v39 offset:38912
  s_waitcnt lgkmcnt(8)
  v_mfma_f32_32x32x16_bf16 v[80:95], v[128:131], v[60:63], v[80:95]
  ds_read_b128 v[56:59], v39 offset:43008
  s_waitcnt lgkmcnt(8)
  v_mfma_f32_32x32x16_bf16 v[96:111], v[128:131], v[8:11], v[96:111]
  ds_read_b128 v[60:63], v39 offset:47104
  s_waitcnt lgkmcnt(8)
  v_mfma_f32_32x32x16_bf16 v[112:127], v[128:131], v[12:15], v[112:127]
  ds_read_b128 v[8:11], v39 offset:35840
  s_waitcnt lgkmcnt(8)
  v_mfma_f32_32x32x16_bf16 v[64:79], v[132:135], v[16:19], v[64:79]
  ds_read_b128 v[12:15], v39 offset:39936
  s_waitcnt lgkmcnt(8)
  v_mfma_f32_32x32x16_bf16 v[80:95], v[132:135], v[20:23], v[80:95]
  ds_read_b128 v[16:19], v39 offset:44032
  s_waitcnt lgkmcnt(8)
  v_mfma_f32_32x32x16_bf16 v[96:111], v[132:135], v[40:43], v[96:111]
  ds_read_b128 v[20:23], v39 offset:48128
  s_waitcnt lgkmcnt(8)
  v_mfma_f32_32x32x16_bf16 v[112:127], v[132:135], v[44:47], v[112:127]
  s_waitcnt lgkmcnt(7)
  v_mfma_f32_32x32x16_bf16 v[64:79], v[136:139], v[48:51], v[64:79]
  s_waitcnt lgkmcnt(0)
  s_barrier
  ds_read_b64_tr_b16 v[144:145], v7 offset:16384
  ds_read_b64_tr_b16 v[146:147], v7 offset:18432
  ds_read_b64_tr_b16 v[148:149], v7 offset:20480
  ds_read_b64_tr_b16 v[150:151], v7 offset:22528
  ds_read_b64_tr_b16 v[152:153], v7 offset:24576
  ds_read_b64_tr_b16 v[154:155], v7 offset:26624
  ds_read_b64_tr_b16 v[156:157], v7 offset:28672
  ds_read_b64_tr_b16 v[158:159], v7 offset:30720
  v_mfma_f32_32x32x16_bf16 v[80:95], v[136:139], v[52:55], v[80:95]
  v_subrev_u32 v39, 65536, v39
  ds_read_b128 v[40:43], v39 offset:32768
  ds_read_b128 v[44:47], v39 offset:36864
  v_mfma_f32_32x32x16_bf16 v[96:111], v[136:139], v[56:59], v[96:111]
  ds_read_b128 v[48:51], v39 offset:40960
  ds_read_b128 v[52:55], v39 offset:45056
  v_mfma_f32_32x32x16_bf16 v[112:127], v[136:139], v[60:63], v[112:127]
  ds_read_b128 v[56:59], v39 offset:33792
  v_mfma_f32_32x32x16_bf16 v[64:79], v[140:143], v[8:11], v[64:79]
  ds_read_b128 v[60:63], v39 offset:37888
  v_mfma_f32_32x32x16_bf16 v[80:95], v[140:143], v[12:15], v[80:95]
  ds_read_b128 v[8:11], v39 offset:41984
  v_mfma_f32_32x32x16_bf16 v[96:111], v[140:143], v[16:19], v[96:111]
  ds_read_b128 v[12:15], v39 offset:46080
  v_mfma_f32_32x32x16_bf16 v[112:127], v[140:143], v[20:23], v[112:127]
  ds_read_b128 v[16:19], v39 offset:34816
  s_waitcnt lgkmcnt(8)
  v_mfma_f32_32x32x16_bf16 v[64:79], v[144:147], v[40:43], v[64:79]
  ds_read_b128 v[20:23], v39 offset:38912
  s_waitcnt lgkmcnt(8)
  v_mfma_f32_32x32x16_bf16 v[80:95], v[144:147], v[44:47], v[80:95]
  ds_read_b128 v[40:43], v39 offset:43008
  s_waitcnt lgkmcnt(8)
  v_mfma_f32_32x32x16_bf16 v[96:111], v[144:147], v[48:51], v[96:111]
  ds_read_b128 v[44:47], v39 offset:47104
  s_waitcnt lgkmcnt(8)
  v_mfma_f32_32x32x16_bf16 v[112:127], v[144:147], v[52:55], v[112:127]
  ds_read_b128 v[48:51], v39 offset:35840
  s_waitcnt lgkmcnt(8)
  v_mfma_f32_32x32x16_bf16 v[64:79], v[148:151], v[56:59], v[64:79]
  ds_read_b128 v[52:55], v39 offset:39936
  s_waitcnt lgkmcnt(8)
  v_mfma_f32_32x32x16_bf16 v[80:95], v[148:151], v[60:63], v[80:95]
  ds_read_b128 v[56:59], v39 offset:44032
  s_waitcnt lgkmcnt(8)
  v_mfma_f32_32x32x16_bf16 v[96:111], v[148:151], v[8:11], v[96:111]
  ds_read_b128 v[60:63], v39 offset:48128
  s_waitcnt lgkmcnt(8)
  v_mfma_f32_32x32x16_bf16 v[112:127], v[148:151], v[12:15], v[112:127]
  s_waitcnt lgkmcnt(7)
  v_mfma_f32_32x32x16_bf16 v[64:79], v[152:155], v[16:19], v[64:79]
  s_waitcnt lgkmcnt(6)
  v_mfma_f32_32x32x16_bf16 v[80:95], v[152:155], v[20:23], v[80:95]
  s_waitcnt lgkmcnt(5)
  v_mfma_f32_32x32x16_bf16 v[96:111], v[152:155], v[40:43], v[96:111]
  s_waitcnt lgkmcnt(4)
  v_mfma_f32_32x32x16_bf16 v[112:127], v[152:155], v[44:47], v[112:127]
  s_waitcnt lgkmcnt(3)
  v_mfma_f32_32x32x16_bf16 v[64:79], v[156:159], v[48:51], v[64:79]
  s_waitcnt lgkmcnt(2)
  v_mfma_f32_32x32x16_bf16 v[80:95], v[156:159], v[52:55], v[80:95]
  s_waitcnt lgkmcnt(1)
  v_mfma_f32_32x32x16_bf16 v[96:111], v[156:159], v[56:59], v[96:111]
  s_waitcnt lgkmcnt(0)
  v_mfma_f32_32x32x16_bf16 v[112:127], v[156:159], v[60:63], v[112:127]
  s_nop 11
  s_branch L_G_final
L_G_final:
  s_lshl_b32 s38, s36, 2
  s_add_u32 s56, s38, s69
  s_lshl_b32 s57, s56, 18
  s_add_u32 s57, s57, 16777216
  s_add_u32 s57, s57, s68
  s_lshl_b32 s56, s56, 11
  s_add_u32 s56, s56, 51380224
  s_lshl_b32 s38, s47, 7
  s_add_u32 s56, s56, s38
  s_lshl_b32 s39, s63, 14
  s_add_u32 s54, s57, s39
  s_cmp_eq_u32 s63, 0
  s_cbranch_scc1 L_G_own0
  buffer_store_dwordx4 v[64:67], v28, s[32:35], s54 offen offset:0 sc1
  buffer_store_dwordx4 v[68:71], v28, s[32:35], s54 offen offset:1024 sc1
  buffer_store_dwordx4 v[72:75], v28, s[32:35], s54 offen offset:2048 sc1
  buffer_store_dwordx4 v[76:79], v28, s[32:35], s54 offen offset:3072 sc1
  s_branch L_G_nx0
L_G_own0:
  v_mov_b32 v128, v64
  v_mov_b32 v129, v65
  v_mov_b32 v130, v66
  v_mov_b32 v131, v67
  v_mov_b32 v132, v68
  v_mov_b32 v133, v69
  v_mov_b32 v134, v70
  v_mov_b32 v135, v71
  v_mov_b32 v136, v72
  v_mov_b32 v137, v73
  v_mov_b32 v138, v74
  v_mov_b32 v139, v75
  v_mov_b32 v140, v76
  v_mov_b32 v141, v77
  v_mov_b32 v142, v78
  v_mov_b32 v143, v79
L_G_nx0:
  s_add_u32 s54, s54, 65536
  s_cmp_eq_u32 s63, 1
  s_cbranch_scc1 L_G_own1
  buffer_store_dwordx4 v[80:83], v28, s[32:35], s54 offen offset:0 sc1
  buffer_store_dwordx4 v[84:87], v28, s[32:35], s54 offen offset:1024 sc1
  buffer_store_dwordx4 v[88:91], v28, s[32:35], s54 offen offset:2048 sc1
  buffer_store_dwordx4 v[92:95], v28, s[32:35], s54 offen offset:3072 sc1
  s_branch L_G_nx1
L_G_own1:
  v_mov_b32 v128, v80
  v_mov_b32 v129, v81
  v_mov_b32 v130, v82
  v_mov_b32 v131, v83
  v_mov_b32 v132, v84
  v_mov_b32 v133, v85
  v_mov_b32 v134, v86
  v_mov_b32 v135, v87
  v_mov_b32 v136, v88
  v_mov_b32 v137, v89
  v_mov_b32 v138, v90
  v_mov_b32 v139, v91
  v_mov_b32 v140, v92
  v_mov_b32 v141, v93
  v_mov_b32 v142, v94
  v_mov_b32 v143, v95
L_G_nx1:
  s_add_u32 s54, s54, 65536
  s_cmp_eq_u32 s63, 2
  s_cbranch_scc1 L_G_own2
  buffer_store_dwordx4 v[96:99], v28, s[32:35], s54 offen offset:0 sc1
  buffer_store_dwordx4 v[100:103], v28, s[32:35], s54 offen offset:1024 sc1
  buffer_store_dwordx4 v[104:107], v28, s[32:35], s54 offen offset:2048 sc1
  buffer_store_dwordx4 v[108:111], v28, s[32:35], s54 offen offset:3072 sc1
  s_branch L_G_nx2
L_G_own2:
  v_mov_b32 v128, v96
  v_mov_b32 v129, v97
  v_mov_b32 v130, v98
  v_mov_b32 v131, v99
  v_mov_b32 v132, v100
  v_mov_b32 v133, v101
  v_mov_b32 v134, v102
  v_mov_b32 v135, v103
  v_mov_b32 v136, v104
  v_mov_b32 v137, v105
  v_mov_b32 v138, v106
  v_mov_b32 v139, v107
  v_mov_b32 v140, v108
  v_mov_b32 v141, v109
  v_mov_b32 v142, v110
  v_mov_b32 v143, v111
L_G_nx2:
  s_add_u32 s54, s54, 65536
  s_cmp_eq_u32 s63, 3
  s_cbranch_scc1 L_G_own3
  buffer_store_dwordx4 v[112:115], v28, s[32:35], s54 offen offset:0 sc1
  buffer_store_dwordx4 v[116:119], v28, s[32:35], s54 offen offset:1024 sc1
  buffer_store_dwordx4 v[120:123], v28, s[32:35], s54 offen offset:2048 sc1
  buffer_store_dwordx4 v[124:127], v28, s[32:35], s54 offen offset:3072 sc1
  s_branch L_G_nx3
L_G_own3:
  v_mov_b32 v128, v112
  v_mov_b32 v129, v113
  v_mov_b32 v130, v114
  v_mov_b32 v131, v115
  v_mov_b32 v132, v116
  v_mov_b32 v133, v117
  v_mov_b32 v134, v118
  v_mov_b32 v135, v119
  v_mov_b32 v136, v120
  v_mov_b32 v137, v121
  v_mov_b32 v138, v122
  v_mov_b32 v139, v123
  v_mov_b32 v140, v124
  v_mov_b32 v141, v125
  v_mov_b32 v142, v126
  v_mov_b32 v143, v127
L_G_nx3:
  v_lshlrev_b32 v49, 7, v29
  s_lshl_b32 s39, s63, 2
  s_add_u32 s38, s56, s39
  v_mov_b32 v48, 1
  s_mov_b64 s[52:53], exec
  s_mov_b64 exec, 15
  s_waitcnt vmcnt(0)
  buffer_store_dword v48, v49, s[32:35], s38 offen sc1
  s_mov_b64 exec, s[52:53]
  s_lshl_b32 s38, s63, 9
  s_add_u32 s56, s56, s38
  v_cmp_ne_u32 s[52:53], s39, v29
  s_mov_b32 s51, 0x20000
L_G_sp2:
  buffer_load_dword v30, v29, s[32:35], s56 offen sc1
  s_waitcnt vmcnt(0)
  v_cmp_ne_u32 vcc, 1, v30
  s_nop 0
  s_and_b64 vcc, vcc, s[52:53]
  s_cbranch_vccz L_G_ok2
  s_sleep 4
  s_sub_u32 s51, s51, 1
  s_cmp_lg_u32 s51, 0
  s_cbranch_scc1 L_G_sp2
L_G_ok2:
  s_lshl_b32 s38, s63, 16
  s_add_u32 s57, s57, s38
  s_add_u32 s38, s63, 1
  s_and_b32 s38, s38, 3
  s_lshl_b32 s38, s38, 14
  s_add_u32 s38, s38, s57
  buffer_load_dwordx4 v[144:147], v28, s[32:35], s38 offen offset:0 sc1
  buffer_load_dwordx4 v[148:151], v28, s[32:35], s38 offen offset:1024 sc1
  buffer_load_dwordx4 v[152:155], v28, s[32:35], s38 offen offset:2048 sc1
  buffer_load_dwordx4 v[156:159], v28, s[32:35], s38 offen offset:3072 sc1
  s_add_u32 s38, s63, 2
  s_and_b32 s38, s38, 3
  s_lshl_b32 s38, s38, 14
  s_add_u32 s38, s38, s57
  buffer_load_dwordx4 v[160:163], v28, s[32:35], s38 offen offset:0 sc1
  buffer_load_dwordx4 v[164:167], v28, s[32:35], s38 offen offset:1024 sc1
  buffer_load_dwordx4 v[168:171], v28, s[32:35], s38 offen offset:2048 sc1
  buffer_load_dwordx4 v[172:175], v28, s[32:35], s38 offen offset:3072 sc1
  s_add_u32 s38, s63, 3
  s_and_b32 s38, s38, 3
  s_lshl_b32 s38, s38, 14
  s_add_u32 s38, s38, s57
  buffer_load_dwordx4 v[176:179], v28, s[32:35], s38 offen offset:0 sc1
  buffer_load_dwordx4 v[180:183], v28, s[32:35], s38 offen offset:1024 sc1
  buffer_load_dwordx4 v[184:187], v28, s[32:35], s38 offen offset:2048 sc1
  buffer_load_dwordx4 v[188:191], v28, s[32:35], s38 offen offset:3072 sc1
  v_and_b32 v48, 31, v0
  v_lshlrev_b32 v48, 10, v48
  v_lshrrev_b32 v49, 5, v0
  v_lshl_add_u32 v48, v49, 4, v48
  s_lshl_b32 s38, s36, 17
  s_lshl_b32 s39, s63, 15
  s_add_u32 s38, s38, s39
  s_lshl_b32 s39, s69, 8
  s_add_u32 s38, s38, s39
  s_lshl_b32 s39, s47, 6
  s_add_u32 s38, s38, s39
  s_waitcnt vmcnt(11)
  v_add_f32 v128, v128, v144
  v_add_f32 v129, v129, v145
  v_add_f32 v130, v130, v146
  v_add_f32 v131, v131, v147
  s_waitcnt vmcnt(10)
  v_add_f32 v132, v132, v148
  v_add_f32 v133, v133, v149
  v_add_f32 v134, v134, v150
  v_add_f32 v135, v135, v151
  s_waitcnt vmcnt(9)
  v_add_f32 v136, v136, v152
  v_add_f32 v137, v137, v153
  v_add_f32 v138, v138, v154
  v_add_f32 v139, v139, v155
  s_waitcnt vmcnt(8)
  v_add_f32 v140, v140, v156
  v_add_f32 v141, v141, v157
  v_add_f32 v142, v142, v158
  v_add_f32 v143, v143, v159
  s_waitcnt vmcnt(7)
  v_add_f32 v128, v128, v160
  v_add_f32 v129, v129, v161
  v_add_f32 v130, v130, v162
  v_add_f32 v131, v131, v163
  s_waitcnt vmcnt(6)
  v_add_f32 v132, v132, v164
  v_add_f32 v133, v133, v165
  v_add_f32 v134, v134, v166
  v_add_f32 v135, v135, v167
  s_waitcnt vmcnt(5)
  v_add_f32 v136, v136, v168
  v_add_f32 v137, v137, v169
  v_add_f32 v138, v138, v170
  v_add_f32 v139, v139, v171
  s_waitcnt vmcnt(4)
  v_add_f32 v140, v140, v172
  v_add_f32 v141, v141, v173
  v_add_f32 v142, v142, v174
  v_add_f32 v143, v143, v175
  s_waitcnt vmcnt(3)
  v_add_f32 v128, v128, v176
  v_add_f32 v129, v129, v177
  v_add_f32 v130, v130, v178
  v_add_f32 v131, v131, v179
  s_waitcnt vmcnt(2)
  v_add_f32 v132, v132, v180
  v_add_f32 v133, v133, v181
  v_add_f32 v134, v134, v182
  v_add_f32 v135, v135, v183
  s_waitcnt vmcnt(1)
  v_add_f32 v136, v136, v184
  v_add_f32 v137, v137, v185
  v_add_f32 v138, v138, v186
  v_add_f32 v139, v139, v187
  s_waitcnt vmcnt(0)
  v_add_f32 v140, v140, v188
  v_add_f32 v141, v141, v189
  v_add_f32 v142, v142, v190
  v_add_f32 v143, v143, v191
  v_cvt_pk_bf16_f32 v128, v128, v129
  v_cvt_pk_bf16_f32 v129, v130, v131
  v_cvt_pk_bf16_f32 v130, v132, v133
  v_cvt_pk_bf16_f32 v131, v134, v135
  v_cvt_pk_bf16_f32 v132, v136, v137
  v_cvt_pk_bf16_f32 v133, v138, v139
  v_cvt_pk_bf16_f32 v134, v140, v141
  v_cvt_pk_bf16_f32 v135, v142, v143
  buffer_store_dwordx4 v[128:131], v48, s[28:31], s38 offen
  buffer_store_dwordx4 v[132:135], v48, s[28:31], s38 offen offset:32
  s_endpgm
L_A:
  v_lshrrev_b32 v16, 5, v0
  v_and_b32 v17, 31, v0
  v_bfe_u32 v18, v0, 1, 3
  v_xor_b32 v18, v18, v16
  v_lshlrev_b32 v18, 4, v18
  v_lshrrev_b32 v19, 2, v17
  v_lshlrev_b32 v19, 10, v19
  v_and_b32 v20, 3, v17
  v_lshl_add_u32 v19, v20, 7, v19
  v_add_u32 v2, v19, v18
  v_xor_b32 v3, 32, v2
  v_xor_b32 v4, 64, v2
  v_xor_b32 v5, 96, v2
  v_lshlrev_b32 v19, 7, v17
  v_add3_u32 v250, v19, v18, s68
  v_xor_b32 v251, 32, v250
  v_xor_b32 v252, 64, v250
  v_xor_b32 v253, 96, v250
  v_bfe_u32 v17, v0, 2, 2
  v_bfe_u32 v18, v0, 3, 1
  v_lshlrev_b32 v18, 6, v18
  v_lshl_add_u32 v18, v17, 7, v18
  v_bfe_u32 v19, v0, 4, 1
  v_lshl_add_u32 v18, v19, 5, v18
  v_and_b32 v19, 3, v0
  v_lshl_add_u32 v20, v19, 3, v18
  v_lshl_add_u32 v6, v16, 10, v20
  v_xor_b32 v7, 64, v6
  v_and_b32 v19, 1, v0
  v_lshl_add_u32 v20, v19, 4, v18
  v_bfe_u32 v19, v0, 1, 1
  v_lshl_add_u32 v20, v19, 3, v20
  v_lshl_add_u32 v11, v16, 11, v20
  v_xor_b32 v12, 64, v11
  v_lshlrev_b32 v14, 4, v0
  v_add_u32 v14, s68, v14
  s_waitcnt lgkmcnt(0)
  s_mov_b32 s8, s76
  s_and_b32 s9, s77, 0xffff
  s_mov_b32 s10, 2097152
  s_mov_b32 s11, 0x20000
  s_mov_b32 s24, s84
  s_and_b32 s25, s85, 0xffff
  s_mov_b32 s26, 4194304
  s_mov_b32 s27, 0x20000
  s_mov_b32 s32, s90
  s_and_b32 s33, s91, 0xffff
  s_mov_b32 s34, 268435456
  s_mov_b32 s35, 0x20000
  s_mov_b32 s99, 0
  s_and_b32 s70, s71, 0
  s_mul_i32 s55, s2, s2
  s_add_u32 s55, s55, s2
  s_mul_i32 s55, s55, 0x27d4eb2f
  s_lshr_b32 s55, s55, 29
  s_lshl_b32 s38, s36, 5
  s_add_u32 s38, s38, s37
  s_lshl_b32 s61, s38, 17
  s_lshl_b32 s62, s38, 15
  s_lshl_b32 s49, s63, 20
  s_lshl_b32 s38, s69, 8
  s_add_u32 s49, s49, s38
  s_lshl_b32 s50, s36, 20
  s_lshl_b32 s38, s63, 18
  s_add_u32 s50, s50, s38
  s_add_u32 s50, s50, s68
  s_lshl_b32 s38, s36, 2
  s_add_u32 s38, s38, s63
  s_lshl_b32 s38, s38, 11
  s_lshl_b32 s39, s47, 7
  s_add_u32 s38, s38, s39
  s_add_u32 s46, s38, 50331648
  s_lshl_b32 s39, s69, 2
  s_add_u32 s45, s46, s39
  s_mov_b32 s66, 0x3e0293ee
  s_mov_b32 s58, 0
  s_mov_b32 s43, 99
  s_mov_b32 s8, s32
  s_mov_b32 s9, s33
  s_mov_b32 s10, 0
  s_waitcnt lgkmcnt(0)
  s_barrier
  ds_read_b128 v[40:43], v250 offset:0
  ds_read_b128 v[44:47], v251 offset:0
  ds_read_b128 v[48:51], v252 offset:0
  ds_read_b128 v[52:55], v253 offset:0
  ds_read_b64_tr_b16 v[16:17], v11 offset:16384
  ds_read_b64_tr_b16 v[18:19], v11 offset:17408
  ds_read_b64_tr_b16 v[20:21], v12 offset:16384
  ds_read_b64_tr_b16 v[22:23], v12 offset:17408
  ds_read_b64_tr_b16 v[24:25], v11 offset:16896
  ds_read_b64_tr_b16 v[26:27], v11 offset:17920
  ds_read_b64_tr_b16 v[28:29], v12 offset:16896
  ds_read_b64_tr_b16 v[30:31], v12 offset:17920
  ds_read_b64_tr_b16 v[32:33], v11 offset:20480
  ds_read_b64_tr_b16 v[34:35], v11 offset:21504
  s_waitcnt lgkmcnt(8)
  v_mfma_f32_32x32x16_bf16 v[104:119], v[16:19], v[40:43], 0
  ds_read_b64_tr_b16 v[36:37], v12 offset:20480
  ds_read_b64_tr_b16 v[38:39], v12 offset:21504
  ds_read_b64_tr_b16 v[232:233], v11 offset:20992
  ds_read_b64_tr_b16 v[234:235], v11 offset:22016
  s_waitcnt lgkmcnt(10)
  v_mfma_f32_32x32x16_bf16 v[120:135], v[20:23], v[40:43], 0
  ds_read_b64_tr_b16 v[236:237], v12 offset:20992
  ds_read_b64_tr_b16 v[238:239], v12 offset:22016
  ds_read_b64_tr_b16 v[240:241], v11 offset:24576
  ds_read_b64_tr_b16 v[242:243], v11 offset:25600
  s_waitcnt lgkmcnt(12)
  v_mfma_f32_32x32x16_bf16 v[136:151], v[24:27], v[40:43], 0
  ds_read_b64_tr_b16 v[244:245], v12 offset:24576
  ds_read_b64_tr_b16 v[246:247], v12 offset:25600
  ds_read_b64_tr_b16 v[16:17], v11 offset:25088
  ds_read_b64_tr_b16 v[18:19], v11 offset:26112
  s_waitcnt lgkmcnt(14)
  v_mfma_f32_32x32x16_bf16 v[152:167], v[28:31], v[40:43], 0
  ds_read_b64_tr_b16 v[20:21], v12 offset:25088
  ds_read_b64_tr_b16 v[22:23], v12 offset:26112
  ds_read_b64_tr_b16 v[24:25], v11 offset:28672
  ds_read_b64_tr_b16 v[26:27], v11 offset:29696
  s_waitcnt lgkmcnt(15)
  v_mfma_f32_32x32x16_bf16 v[104:119], v[32:35], v[44:47], v[104:119]
  ds_read_b64_tr_b16 v[28:29], v12 offset:28672
  ds_read_b64_tr_b16 v[30:31], v12 offset:29696
  s_waitcnt lgkmcnt(15)
  v_mfma_f32_32x32x16_bf16 v[120:135], v[36:39], v[44:47], v[120:135]
  ds_read_b64_tr_b16 v[32:33], v11 offset:29184
  ds_read_b64_tr_b16 v[34:35], v11 offset:30208
  s_waitcnt lgkmcnt(15)
  v_mfma_f32_32x32x16_bf16 v[136:151], v[232:235], v[44:47], v[136:151]
  ds_read_b64_tr_b16 v[36:37], v12 offset:29184
  ds_read_b64_tr_b16 v[38:39], v12 offset:30208
  s_waitcnt lgkmcnt(15)
  v_mfma_f32_32x32x16_bf16 v[152:167], v[236:239], v[44:47], v[152:167]
  s_waitcnt lgkmcnt(14)
  v_mfma_f32_32x32x16_bf16 v[104:119], v[240:243], v[48:51], v[104:119]
  s_waitcnt lgkmcnt(0)
  s_barrier
  v_mfma_f32_32x32x16_bf16 v[120:135], v[244:247], v[48:51], v[120:135]
  ds_read_b64_tr_b16 v[232:233], v11 offset:32768
  ds_read_b64_tr_b16 v[234:235], v11 offset:33792
  ds_read_b64_tr_b16 v[236:237], v12 offset:32768
  ds_read_b64_tr_b16 v[238:239], v12 offset:33792
  v_mfma_f32_32x32x16_bf16 v[136:151], v[16:19], v[48:51], v[136:151]
  ds_read_b64_tr_b16 v[240:241], v11 offset:33280
  ds_read_b64_tr_b16 v[242:243], v11 offset:34304
  ds_read_b64_tr_b16 v[244:245], v12 offset:33280
  ds_read_b64_tr_b16 v[246:247], v12 offset:34304
  v_mfma_f32_32x32x16_bf16 v[152:167], v[20:23], v[48:51], v[152:167]
  ds_read_b64_tr_b16 v[16:17], v11 offset:36864
  ds_read_b64_tr_b16 v[18:19], v11 offset:37888
  v_mfma_f32_32x32x16_bf16 v[104:119], v[24:27], v[52:55], v[104:119]
  ds_read_b64_tr_b16 v[20:21], v12 offset:36864
  ds_read_b64_tr_b16 v[22:23], v12 offset:37888
  v_mfma_f32_32x32x16_bf16 v[120:135], v[28:31], v[52:55], v[120:135]
  ds_read_b64_tr_b16 v[24:25], v11 offset:37376
  ds_read_b64_tr_b16 v[26:27], v11 offset:38400
  v_mfma_f32_32x32x16_bf16 v[136:151], v[32:35], v[52:55], v[136:151]
  ds_read_b64_tr_b16 v[28:29], v12 offset:37376
  ds_read_b64_tr_b16 v[30:31], v12 offset:38400
  v_mfma_f32_32x32x16_bf16 v[152:167], v[36:39], v[52:55], v[152:167]
  ds_read_b64_tr_b16 v[32:33], v11 offset:40960
  ds_read_b64_tr_b16 v[34:35], v11 offset:41984
  s_waitcnt lgkmcnt(15)
  v_mfma_f32_32x32x16_bf16 v[168:183], v[232:235], v[40:43], 0
  ds_read_b64_tr_b16 v[36:37], v12 offset:40960
  ds_read_b64_tr_b16 v[38:39], v12 offset:41984
  s_waitcnt lgkmcnt(15)
  v_mfma_f32_32x32x16_bf16 v[184:199], v[236:239], v[40:43], 0
  ds_read_b64_tr_b16 v[232:233], v11 offset:41472
  ds_read_b64_tr_b16 v[234:235], v11 offset:42496
  s_waitcnt lgkmcnt(15)
  v_mfma_f32_32x32x16_bf16 v[200:215], v[240:243], v[40:43], 0
  ds_read_b64_tr_b16 v[236:237], v12 offset:41472
  ds_read_b64_tr_b16 v[238:239], v12 offset:42496
  s_waitcnt lgkmcnt(15)
  v_mfma_f32_32x32x16_bf16 v[216:231], v[244:247], v[40:43], 0
  ds_read_b64_tr_b16 v[240:241], v11 offset:45056
  ds_read_b64_tr_b16 v[242:243], v11 offset:46080
  s_waitcnt lgkmcnt(15)
  v_mfma_f32_32x32x16_bf16 v[168:183], v[16:19], v[44:47], v[168:183]
  ds_read_b64_tr_b16 v[244:245], v12 offset:45056
  ds_read_b64_tr_b16 v[246:247], v12 offset:46080
  s_waitcnt lgkmcnt(15)
  v_mfma_f32_32x32x16_bf16 v[184:199], v[20:23], v[44:47], v[184:199]
  ds_read_b64_tr_b16 v[16:17], v11 offset:45568
  ds_read_b64_tr_b16 v[18:19], v11 offset:46592
  s_waitcnt lgkmcnt(15)
  v_mfma_f32_32x32x16_bf16 v[200:215], v[24:27], v[44:47], v[200:215]
  ds_read_b64_tr_b16 v[20:21], v12 offset:45568
  ds_read_b64_tr_b16 v[22:23], v12 offset:46592
  s_waitcnt lgkmcnt(15)
  v_mfma_f32_32x32x16_bf16 v[216:231], v[28:31], v[44:47], v[216:231]
  s_waitcnt lgkmcnt(14)
  v_mfma_f32_32x32x16_bf16 v[168:183], v[32:35], v[48:51], v[168:183]
  s_waitcnt lgkmcnt(0)
  s_barrier
  ds_read_b128 v[56:59], v250 offset:49152
  ds_read_b128 v[60:63], v251 offset:49152
  ds_read_b128 v[64:67], v252 offset:49152
  ds_read_b128 v[68:71], v253 offset:49152
  v_mfma_f32_32x32x16_bf16 v[184:199], v[36:39], v[48:51], v[184:199]
  v_add_u32 v11, 65536, v11
  v_add_u32 v12, 65536, v12
  ds_read_b64_tr_b16 v[24:25], v11 offset:0
  ds_read_b64_tr_b16 v[26:27], v11 offset:1024
  ds_read_b64_tr_b16 v[28:29], v12 offset:0
  ds_read_b64_tr_b16 v[30:31], v12 offset:1024
  v_mfma_f32_32x32x16_bf16 v[200:215], v[232:235], v[48:51], v[200:215]
  ds_read_b64_tr_b16 v[32:33], v11 offset:512
  ds_read_b64_tr_b16 v[34:35], v11 offset:1536
  ds_read_b64_tr_b16 v[36:37], v12 offset:512
  ds_read_b64_tr_b16 v[38:39], v12 offset:1536
  v_mfma_f32_32x32x16_bf16 v[216:231], v[236:239], v[48:51], v[216:231]
  ds_read_b64_tr_b16 v[232:233], v11 offset:4096
  ds_read_b64_tr_b16 v[234:235], v11 offset:5120
  v_mfma_f32_32x32x16_bf16 v[168:183], v[240:243], v[52:55], v[168:183]
  ds_read_b64_tr_b16 v[236:237], v12 offset:4096
  ds_read_b64_tr_b16 v[238:239], v12 offset:5120
  v_mfma_f32_32x32x16_bf16 v[184:199], v[244:247], v[52:55], v[184:199]
  ds_read_b64_tr_b16 v[240:241], v11 offset:4608
  ds_read_b64_tr_b16 v[242:243], v11 offset:5632
  v_mfma_f32_32x32x16_bf16 v[200:215], v[16:19], v[52:55], v[200:215]
  ds_read_b64_tr_b16 v[244:245], v12 offset:4608
  ds_read_b64_tr_b16 v[246:247], v12 offset:5632
  v_mfma_f32_32x32x16_bf16 v[216:231], v[20:23], v[52:55], v[216:231]
  ds_read_b64_tr_b16 v[16:17], v11 offset:8192
  ds_read_b64_tr_b16 v[18:19], v11 offset:9216
  s_waitcnt lgkmcnt(15)
  v_mfma_f32_32x32x16_bf16 v[104:119], v[24:27], v[56:59], v[104:119]
  ds_read_b64_tr_b16 v[20:21], v12 offset:8192
  ds_read_b64_tr_b16 v[22:23], v12 offset:9216
  s_waitcnt lgkmcnt(15)
  v_mfma_f32_32x32x16_bf16 v[120:135], v[28:31], v[56:59], v[120:135]
  ds_read_b64_tr_b16 v[24:25], v11 offset:8704
  ds_read_b64_tr_b16 v[26:27], v11 offset:9728
  s_waitcnt lgkmcnt(15)
  v_mfma_f32_32x32x16_bf16 v[136:151], v[32:35], v[56:59], v[136:151]
  ds_read_b64_tr_b16 v[28:29], v12 offset:8704
  ds_read_b64_tr_b16 v[30:31], v12 offset:9728
  s_waitcnt lgkmcnt(15)
  v_mfma_f32_32x32x16_bf16 v[152:167], v[36:39], v[56:59], v[152:167]
  ds_read_b64_tr_b16 v[32:33], v11 offset:12288
  ds_read_b64_tr_b16 v[34:35], v11 offset:13312
  s_waitcnt lgkmcnt(15)
  v_mfma_f32_32x32x16_bf16 v[104:119], v[232:235], v[60:63], v[104:119]
  ds_read_b64_tr_b16 v[36:37], v12 offset:12288
  ds_read_b64_tr_b16 v[38:39], v12 offset:13312
  s_waitcnt lgkmcnt(15)
  v_mfma_f32_32x32x16_bf16 v[120:135], v[236:239], v[60:63], v[120:135]
  ds_read_b64_tr_b16 v[232:233], v11 offset:12800
  ds_read_b64_tr_b16 v[234:235], v11 offset:13824
  s_waitcnt lgkmcnt(15)
  v_mfma_f32_32x32x16_bf16 v[136:151], v[240:243], v[60:63], v[136:151]
  ds_read_b64_tr_b16 v[236:237], v12 offset:12800
  ds_read_b64_tr_b16 v[238:239], v12 offset:13824
  s_waitcnt lgkmcnt(15)
  v_mfma_f32_32x32x16_bf16 v[152:167], v[244:247], v[60:63], v[152:167]
  s_waitcnt lgkmcnt(14)
  v_mfma_f32_32x32x16_bf16 v[104:119], v[16:19], v[64:67], v[104:119]
  s_waitcnt lgkmcnt(0)
  s_barrier
  v_mfma_f32_32x32x16_bf16 v[120:135], v[20:23], v[64:67], v[120:135]
  ds_read_b64_tr_b16 v[240:241], v11 offset:16384
  ds_read_b64_tr_b16 v[242:243], v11 offset:17408
  ds_read_b64_tr_b16 v[244:245], v12 offset:16384
  ds_read_b64_tr_b16 v[246:247], v12 offset:17408
  v_mfma_f32_32x32x16_bf16 v[136:151], v[24:27], v[64:67], v[136:151]
  ds_read_b64_tr_b16 v[16:17], v11 offset:16896
  ds_read_b64_tr_b16 v[18:19], v11 offset:17920
  ds_read_b64_tr_b16 v[20:21], v12 offset:16896
  ds_read_b64_tr_b16 v[22:23], v12 offset:17920
  v_mfma_f32_32x32x16_bf16 v[152:167], v[28:31], v[64:67], v[152:167]
  ds_read_b64_tr_b16 v[24:25], v11 offset:20480
  ds_read_b64_tr_b16 v[26:27], v11 offset:21504
  v_mfma_f32_32x32x16_bf16 v[104:119], v[32:35], v[68:71], v[104:119]
  ds_read_b64_tr_b16 v[28:29], v12 offset:20480
  ds_read_b64_tr_b16 v[30:31], v12 offset:21504
  v_mfma_f32_32x32x16_bf16 v[120:135], v[36:39], v[68:71], v[120:135]
  ds_read_b64_tr_b16 v[32:33], v11 offset:20992
  ds_read_b64_tr_b16 v[34:35], v11 offset:22016
  v_mfma_f32_32x32x16_bf16 v[136:151], v[232:235], v[68:71], v[136:151]
  ds_read_b64_tr_b16 v[36:37], v12 offset:20992
  ds_read_b64_tr_b16 v[38:39], v12 offset:22016
  v_mfma_f32_32x32x16_bf16 v[152:167], v[236:239], v[68:71], v[152:167]
  ds_read_b64_tr_b16 v[232:233], v11 offset:24576
  ds_read_b64_tr_b16 v[234:235], v11 offset:25600
  s_waitcnt lgkmcnt(15)
  v_mfma_f32_32x32x16_bf16 v[168:183], v[240:243], v[56:59], v[168:183]
  ds_read_b64_tr_b16 v[236:237], v12 offset:24576
  ds_read_b64_tr_b16 v[238:239], v12 offset:25600
  s_waitcnt lgkmcnt(15)
  v_mfma_f32_32x32x16_bf16 v[184:199], v[244:247], v[56:59], v[184:199]
  ds_read_b64_tr_b16 v[240:241], v11 offset:25088
  ds_read_b64_tr_b16 v[242:243], v11 offset:26112
  s_waitcnt lgkmcnt(15)
  v_mfma_f32_32x32x16_bf16 v[200:215], v[16:19], v[56:59], v[200:215]
  ds_read_b64_tr_b16 v[244:245], v12 offset:25088
  ds_read_b64_tr_b16 v[246:247], v12 offset:26112
  s_waitcnt lgkmcnt(15)
  v_mfma_f32_32x32x16_bf16 v[216:231], v[20:23], v[56:59], v[216:231]
  ds_read_b64_tr_b16 v[16:17], v11 offset:28672
  ds_read_b64_tr_b16 v[18:19], v11 offset:29696
  s_waitcnt lgkmcnt(15)
  v_mfma_f32_32x32x16_bf16 v[168:183], v[24:27], v[60:63], v[168:183]
  ds_read_b64_tr_b16 v[20:21], v12 offset:28672
  ds_read_b64_tr_b16 v[22:23], v12 offset:29696
  s_waitcnt lgkmcnt(15)
  v_mfma_f32_32x32x16_bf16 v[184:199], v[28:31], v[60:63], v[184:199]
  ds_read_b64_tr_b16 v[24:25], v11 offset:29184
  ds_read_b64_tr_b16 v[26:27], v11 offset:30208
  s_waitcnt lgkmcnt(15)
  v_mfma_f32_32x32x16_bf16 v[200:215], v[32:35], v[60:63], v[200:215]
  ds_read_b64_tr_b16 v[28:29], v12 offset:29184
  ds_read_b64_tr_b16 v[30:31], v12 offset:30208
  s_waitcnt lgkmcnt(15)
  v_mfma_f32_32x32x16_bf16 v[216:231], v[36:39], v[60:63], v[216:231]
  s_waitcnt lgkmcnt(14)
  v_mfma_f32_32x32x16_bf16 v[168:183], v[232:235], v[64:67], v[168:183]
  s_waitcnt lgkmcnt(0)
  s_barrier
  v_add_u32 v250, 65536, v250
  v_add_u32 v251, 65536, v251
  v_add_u32 v252, 65536, v252
  v_add_u32 v253, 65536, v253
  ds_read_b128 v[40:43], v250 offset:32768
  ds_read_b128 v[44:47], v251 offset:32768
  ds_read_b128 v[48:51], v252 offset:32768
  ds_read_b128 v[52:55], v253 offset:32768
  v_mfma_f32_32x32x16_bf16 v[184:199], v[236:239], v[64:67], v[184:199]
  v_subrev_u32 v11, 65536, v11
  v_subrev_u32 v12, 65536, v12
  ds_read_b64_tr_b16 v[32:33], v11 offset:0
  ds_read_b64_tr_b16 v[34:35], v11 offset:1024
  ds_read_b64_tr_b16 v[36:37], v12 offset:0
  ds_read_b64_tr_b16 v[38:39], v12 offset:1024
  v_mfma_f32_32x32x16_bf16 v[200:215], v[240:243], v[64:67], v[200:215]
  ds_read_b64_tr_b16 v[232:233], v11 offset:512
  ds_read_b64_tr_b16 v[234:235], v11 offset:1536
  ds_read_b64_tr_b16 v[236:237], v12 offset:512
  ds_read_b64_tr_b16 v[238:239], v12 offset:1536
  v_mfma_f32_32x32x16_bf16 v[216:231], v[244:247], v[64:67], v[216:231]
  ds_read_b64_tr_b16 v[240:241], v11 offset:4096
  ds_read_b64_tr_b16 v[242:243], v11 offset:5120
  v_mfma_f32_32x32x16_bf16 v[168:183], v[16:19], v[68:71], v[168:183]
  ds_read_b64_tr_b16 v[244:245], v12 offset:4096
  ds_read_b64_tr_b16 v[246:247], v12 offset:5120
  v_mfma_f32_32x32x16_bf16 v[184:199], v[20:23], v[68:71], v[184:199]
  ds_read_b64_tr_b16 v[16:17], v11 offset:4608
  ds_read_b64_tr_b16 v[18:19], v11 offset:5632
  v_mfma_f32_32x32x16_bf16 v[200:215], v[24:27], v[68:71], v[200:215]
  ds_read_b64_tr_b16 v[20:21], v12 offset:4608
  ds_read_b64_tr_b16 v[22:23], v12 offset:5632
  v_mfma_f32_32x32x16_bf16 v[216:231], v[28:31], v[68:71], v[216:231]
  ds_read_b64_tr_b16 v[24:25], v11 offset:8192
  ds_read_b64_tr_b16 v[26:27], v11 offset:9216
  s_waitcnt lgkmcnt(15)
  v_mfma_f32_32x32x16_bf16 v[104:119], v[32:35], v[40:43], v[104:119]
  ds_read_b64_tr_b16 v[28:29], v12 offset:8192
  ds_read_b64_tr_b16 v[30:31], v12 offset:9216
  s_waitcnt lgkmcnt(15)
  v_mfma_f32_32x32x16_bf16 v[120:135], v[36:39], v[40:43], v[120:135]
  ds_read_b64_tr_b16 v[32:33], v11 offset:8704
  ds_read_b64_tr_b16 v[34:35], v11 offset:9728
  s_waitcnt lgkmcnt(15)
  v_mfma_f32_32x32x16_bf16 v[136:151], v[232:235], v[40:43], v[136:151]
  ds_read_b64_tr_b16 v[36:37], v12 offset:8704
  ds_read_b64_tr_b16 v[38:39], v12 offset:9728
  s_waitcnt lgkmcnt(15)
  v_mfma_f32_32x32x16_bf16 v[152:167], v[236:239], v[40:43], v[152:167]
  ds_read_b64_tr_b16 v[232:233], v11 offset:12288
  ds_read_b64_tr_b16 v[234:235], v11 offset:13312
  s_waitcnt lgkmcnt(15)
  v_mfma_f32_32x32x16_bf16 v[104:119], v[240:243], v[44:47], v[104:119]
  ds_read_b64_tr_b16 v[236:237], v12 offset:12288
  ds_read_b64_tr_b16 v[238:239], v12 offset:13312
  s_waitcnt lgkmcnt(15)
  v_mfma_f32_32x32x16_bf16 v[120:135], v[244:247], v[44:47], v[120:135]
  ds_read_b64_tr_b16 v[240:241], v11 offset:12800
  ds_read_b64_tr_b16 v[242:243], v11 offset:13824
  s_waitcnt lgkmcnt(15)
  v_mfma_f32_32x32x16_bf16 v[136:151], v[16:19], v[44:47], v[136:151]
  ds_read_b64_tr_b16 v[244:245], v12 offset:12800
  ds_read_b64_tr_b16 v[246:247], v12 offset:13824
  s_waitcnt lgkmcnt(15)
  v_mfma_f32_32x32x16_bf16 v[152:167], v[20:23], v[44:47], v[152:167]
  s_waitcnt lgkmcnt(14)
  v_mfma_f32_32x32x16_bf16 v[104:119], v[24:27], v[48:51], v[104:119]
  s_waitcnt lgkmcnt(0)
  s_barrier
  v_mfma_f32_32x32x16_bf16 v[120:135], v[28:31], v[48:51], v[120:135]
  ds_read_b64_tr_b16 v[16:17], v11 offset:16384
  ds_read_b64_tr_b16 v[18:19], v11 offset:17408
  ds_read_b64_tr_b16 v[20:21], v12 offset:16384
  ds_read_b64_tr_b16 v[22:23], v12 offset:17408
  v_mfma_f32_32x32x16_bf16 v[136:151], v[32:35], v[48:51], v[136:151]
  ds_read_b64_tr_b16 v[24:25], v11 offset:16896
  ds_read_b64_tr_b16 v[26:27], v11 offset:17920
  ds_read_b64_tr_b16 v[28:29], v12 offset:16896
  ds_read_b64_tr_b16 v[30:31], v12 offset:17920
  v_mfma_f32_32x32x16_bf16 v[152:167], v[36:39], v[48:51], v[152:167]
  ds_read_b64_tr_b16 v[32:33], v11 offset:20480
  ds_read_b64_tr_b16 v[34:35], v11 offset:21504
  v_mfma_f32_32x32x16_bf16 v[104:119], v[232:235], v[52:55], v[104:119]
  ds_read_b64_tr_b16 v[36:37], v12 offset:20480
  ds_read_b64_tr_b16 v[38:39], v12 offset:21504
  v_mfma_f32_32x32x16_bf16 v[120:135], v[236:239], v[52:55], v[120:135]
  ds_read_b64_tr_b16 v[232:233], v11 offset:20992
  ds_read_b64_tr_b16 v[234:235], v11 offset:22016
  v_mfma_f32_32x32x16_bf16 v[136:151], v[240:243], v[52:55], v[136:151]
  ds_read_b64_tr_b16 v[236:237], v12 offset:20992
  ds_read_b64_tr_b16 v[238:239], v12 offset:22016
  v_mfma_f32_32x32x16_bf16 v[152:167], v[244:247], v[52:55], v[152:167]
  ds_read_b64_tr_b16 v[240:241], v11 offset:24576
  ds_read_b64_tr_b16 v[242:243], v11 offset:25600
  s_waitcnt lgkmcnt(15)
  v_mfma_f32_32x32x16_bf16 v[168:183], v[16:19], v[40:43], v[168:183]
  ds_read_b64_tr_b16 v[244:245], v12 offset:24576
  ds_read_b64_tr_b16 v[246:247], v12 offset:25600
  s_waitcnt lgkmcnt(15)
  v_mfma_f32_32x32x16_bf16 v[184:199], v[20:23], v[40:43], v[184:199]
  ds_read_b64_tr_b16 v[16:17], v11 offset:25088
  ds_read_b64_tr_b16 v[18:19], v11 offset:26112
  s_waitcnt lgkmcnt(15)
  v_mfma_f32_32x32x16_bf16 v[200:215], v[24:27], v[40:43], v[200:215]
  ds_read_b64_tr_b16 v[20:21], v12 offset:25088
  ds_read_b64_tr_b16 v[22:23], v12 offset:26112
  s_waitcnt lgkmcnt(15)
  v_mfma_f32_32x32x16_bf16 v[216:231], v[28:31], v[40:43], v[216:231]
  ds_read_b64_tr_b16 v[24:25], v11 offset:28672
  ds_read_b64_tr_b16 v[26:27], v11 offset:29696
  s_waitcnt lgkmcnt(15)
  v_mfma_f32_32x32x16_bf16 v[168:183], v[32:35], v[44:47], v[168:183]
  ds_read_b64_tr_b16 v[28:29], v12 offset:28672
  ds_read_b64_tr_b16 v[30:31], v12 offset:29696
  s_waitcnt lgkmcnt(15)
  v_mfma_f32_32x32x16_bf16 v[184:199], v[36:39], v[44:47], v[184:199]
  ds_read_b64_tr_b16 v[32:33], v11 offset:29184
  ds_read_b64_tr_b16 v[34:35], v11 offset:30208
  s_waitcnt lgkmcnt(15)
  v_mfma_f32_32x32x16_bf16 v[200:215], v[232:235], v[44:47], v[200:215]
  ds_read_b64_tr_b16 v[36:37], v12 offset:29184
  ds_read_b64_tr_b16 v[38:39], v12 offset:30208
  s_waitcnt lgkmcnt(15)
  v_mfma_f32_32x32x16_bf16 v[216:231], v[236:239], v[44:47], v[216:231]
  s_waitcnt lgkmcnt(14)
  v_mfma_f32_32x32x16_bf16 v[168:183], v[240:243], v[48:51], v[168:183]
  s_waitcnt lgkmcnt(0)
  s_barrier
  v_subrev_u32 v250, 65536, v250
  v_subrev_u32 v251, 65536, v251
  v_subrev_u32 v252, 65536, v252
  v_subrev_u32 v253, 65536, v253
  ds_read_b128 v[56:59], v250 offset:32768
  ds_read_b128 v[60:63], v251 offset:32768
  ds_read_b128 v[64:67], v252 offset:32768
  ds_read_b128 v[68:71], v253 offset:32768
  v_mfma_f32_32x32x16_bf16 v[184:199], v[244:247], v[48:51], v[184:199]
  ds_read_b64_tr_b16 v[232:233], v11 offset:49152
  ds_read_b64_tr_b16 v[234:235], v11 offset:50176
  ds_read_b64_tr_b16 v[236:237], v12 offset:49152
  ds_read_b64_tr_b16 v[238:239], v12 offset:50176
  v_mfma_f32_32x32x16_bf16 v[200:215], v[16:19], v[48:51], v[200:215]
  ds_read_b64_tr_b16 v[240:241], v11 offset:49664
  ds_read_b64_tr_b16 v[242:243], v11 offset:50688
  ds_read_b64_tr_b16 v[244:245], v12 offset:49664
  ds_read_b64_tr_b16 v[246:247], v12 offset:50688
  v_mfma_f32_32x32x16_bf16 v[216:231], v[20:23], v[48:51], v[216:231]
  ds_read_b64_tr_b16 v[16:17], v11 offset:53248
  ds_read_b64_tr_b16 v[18:19], v11 offset:54272
  v_mfma_f32_32x32x16_bf16 v[168:183], v[24:27], v[52:55], v[168:183]
  ds_read_b64_tr_b16 v[20:21], v12 offset:53248
  ds_read_b64_tr_b16 v[22:23], v12 offset:54272
  v_mfma_f32_32x32x16_bf16 v[184:199], v[28:31], v[52:55], v[184:199]
  ds_read_b64_tr_b16 v[24:25], v11 offset:53760
  ds_read_b64_tr_b16 v[26:27], v11 offset:54784
  v_mfma_f32_32x32x16_bf16 v[200:215], v[32:35], v[52:55], v[200:215]
  ds_read_b64_tr_b16 v[28:29], v12 offset:53760
  ds_read_b64_tr_b16 v[30:31], v12 offset:54784
  v_mfma_f32_32x32x16_bf16 v[216:231], v[36:39], v[52:55], v[216:231]
  ds_read_b64_tr_b16 v[32:33], v11 offset:57344
  ds_read_b64_tr_b16 v[34:35], v11 offset:58368
  s_waitcnt lgkmcnt(15)
  v_mfma_f32_32x32x16_bf16 v[104:119], v[232:235], v[56:59], v[104:119]
  ds_read_b64_tr_b16 v[36:37], v12 offset:57344
  ds_read_b64_tr_b16 v[38:39], v12 offset:58368
  s_waitcnt lgkmcnt(15)
  v_mfma_f32_32x32x16_bf16 v[120:135], v[236:239], v[56:59], v[120:135]
  ds_read_b64_tr_b16 v[232:233], v11 offset:57856
  ds_read_b64_tr_b16 v[234:235], v11 offset:58880
  s_waitcnt lgkmcnt(15)
  v_mfma_f32_32x32x16_bf16 v[136:151], v[240:243], v[56:59], v[136:151]
  ds_read_b64_tr_b16 v[236:237], v12 offset:57856
  ds_read_b64_tr_b16 v[238:239], v12 offset:58880
  s_waitcnt lgkmcnt(15)
  v_mfma_f32_32x32x16_bf16 v[152:167], v[244:247], v[56:59], v[152:167]
  ds_read_b64_tr_b16 v[240:241], v11 offset:61440
  ds_read_b64_tr_b16 v[242:243], v11 offset:62464
  s_waitcnt lgkmcnt(15)
  v_mfma_f32_32x32x16_bf16 v[104:119], v[16:19], v[60:63], v[104:119]
  ds_read_b64_tr_b16 v[244:245], v12 offset:61440
  ds_read_b64_tr_b16 v[246:247], v12 offset:62464
  s_waitcnt lgkmcnt(15)
  v_mfma_f32_32x32x16_bf16 v[120:135], v[20:23], v[60:63], v[120:135]
  ds_read_b64_tr_b16 v[16:17], v11 offset:61952
  ds_read_b64_tr_b16 v[18:19], v11 offset:62976
  s_waitcnt lgkmcnt(15)
  v_mfma_f32_32x32x16_bf16 v[136:151], v[24:27], v[60:63], v[136:151]
  ds_read_b64_tr_b16 v[20:21], v12 offset:61952
  ds_read_b64_tr_b16 v[22:23], v12 offset:62976
  s_waitcnt lgkmcnt(15)
  v_mfma_f32_32x32x16_bf16 v[152:167], v[28:31], v[60:63], v[152:167]
  s_waitcnt lgkmcnt(14)
  v_mfma_f32_32x32x16_bf16 v[104:119], v[32:35], v[64:67], v[104:119]
  s_waitcnt lgkmcnt(0)
  s_barrier
  v_mfma_f32_32x32x16_bf16 v[120:135], v[36:39], v[64:67], v[120:135]
  v_add_u32 v11, 65536, v11
  v_add_u32 v12, 65536, v12
  ds_read_b64_tr_b16 v[24:25], v11 offset:0
  ds_read_b64_tr_b16 v[26:27], v11 offset:1024
  ds_read_b64_tr_b16 v[28:29], v12 offset:0
  ds_read_b64_tr_b16 v[30:31], v12 offset:1024
  v_mfma_f32_32x32x16_bf16 v[136:151], v[232:235], v[64:67], v[136:151]
  ds_read_b64_tr_b16 v[32:33], v11 offset:512
  ds_read_b64_tr_b16 v[34:35], v11 offset:1536
  ds_read_b64_tr_b16 v[36:37], v12 offset:512
  ds_read_b64_tr_b16 v[38:39], v12 offset:1536
  v_mfma_f32_32x32x16_bf16 v[152:167], v[236:239], v[64:67], v[152:167]
  ds_read_b64_tr_b16 v[232:233], v11 offset:4096
  ds_read_b64_tr_b16 v[234:235], v11 offset:5120
  v_mfma_f32_32x32x16_bf16 v[104:119], v[240:243], v[68:71], v[104:119]
  ds_read_b64_tr_b16 v[236:237], v12 offset:4096
  ds_read_b64_tr_b16 v[238:239], v12 offset:5120
  v_mfma_f32_32x32x16_bf16 v[120:135], v[244:247], v[68:71], v[120:135]
  ds_read_b64_tr_b16 v[240:241], v11 offset:4608
  ds_read_b64_tr_b16 v[242:243], v11 offset:5632
  v_mfma_f32_32x32x16_bf16 v[136:151], v[16:19], v[68:71], v[136:151]
  ds_read_b64_tr_b16 v[244:245], v12 offset:4608
  ds_read_b64_tr_b16 v[246:247], v12 offset:5632
  v_mfma_f32_32x32x16_bf16 v[152:167], v[20:23], v[68:71], v[152:167]
  ds_read_b64_tr_b16 v[16:17], v11 offset:8192
  ds_read_b64_tr_b16 v[18:19], v11 offset:9216
  s_waitcnt lgkmcnt(15)
  v_mfma_f32_32x32x16_bf16 v[168:183], v[24:27], v[56:59], v[168:183]
  ds_read_b64_tr_b16 v[20:21], v12 offset:8192
  ds_read_b64_tr_b16 v[22:23], v12 offset:9216
  s_waitcnt lgkmcnt(15)
  v_mfma_f32_32x32x16_bf16 v[184:199], v[28:31], v[56:59], v[184:199]
  ds_read_b64_tr_b16 v[24:25], v11 offset:8704
  ds_read_b64_tr_b16 v[26:27], v11 offset:9728
  s_waitcnt lgkmcnt(15)
  v_mfma_f32_32x32x16_bf16 v[200:215], v[32:35], v[56:59], v[200:215]
  ds_read_b64_tr_b16 v[28:29], v12 offset:8704
  ds_read_b64_tr_b16 v[30:31], v12 offset:9728
  s_waitcnt lgkmcnt(15)
  v_mfma_f32_32x32x16_bf16 v[216:231], v[36:39], v[56:59], v[216:231]
  ds_read_b64_tr_b16 v[32:33], v11 offset:12288
  ds_read_b64_tr_b16 v[34:35], v11 offset:13312
  s_waitcnt lgkmcnt(15)
  v_mfma_f32_32x32x16_bf16 v[168:183], v[232:235], v[60:63], v[168:183]
  ds_read_b64_tr_b16 v[36:37], v12 offset:12288
  ds_read_b64_tr_b16 v[38:39], v12 offset:13312
  s_waitcnt lgkmcnt(15)
  v_mfma_f32_32x32x16_bf16 v[184:199], v[236:239], v[60:63], v[184:199]
  ds_read_b64_tr_b16 v[232:233], v11 offset:12800
  ds_read_b64_tr_b16 v[234:235], v11 offset:13824
  s_waitcnt lgkmcnt(15)
  v_mfma_f32_32x32x16_bf16 v[200:215], v[240:243], v[60:63], v[200:215]
  ds_read_b64_tr_b16 v[236:237], v12 offset:12800
  ds_read_b64_tr_b16 v[238:239], v12 offset:13824
  s_waitcnt lgkmcnt(15)
  v_mfma_f32_32x32x16_bf16 v[216:231], v[244:247], v[60:63], v[216:231]
  s_waitcnt lgkmcnt(14)
  v_mfma_f32_32x32x16_bf16 v[168:183], v[16:19], v[64:67], v[168:183]
  s_waitcnt lgkmcnt(0)
  s_barrier
  v_add_u32 v250, 65536, v250
  v_add_u32 v251, 65536, v251
  v_add_u32 v252, 65536, v252
  v_add_u32 v253, 65536, v253
  ds_read_b128 v[40:43], v250 offset:16384
  ds_read_b128 v[44:47], v251 offset:16384
  ds_read_b128 v[48:51], v252 offset:16384
  ds_read_b128 v[52:55], v253 offset:16384
  v_mfma_f32_32x32x16_bf16 v[184:199], v[20:23], v[64:67], v[184:199]
  ds_read_b64_tr_b16 v[240:241], v11 offset:32768
  ds_read_b64_tr_b16 v[242:243], v11 offset:33792
  ds_read_b64_tr_b16 v[244:245], v12 offset:32768
  ds_read_b64_tr_b16 v[246:247], v12 offset:33792
  v_mfma_f32_32x32x16_bf16 v[200:215], v[24:27], v[64:67], v[200:215]
  ds_read_b64_tr_b16 v[16:17], v11 offset:33280
  ds_read_b64_tr_b16 v[18:19], v11 offset:34304
  ds_read_b64_tr_b16 v[20:21], v12 offset:33280
  ds_read_b64_tr_b16 v[22:23], v12 offset:34304
  v_mfma_f32_32x32x16_bf16 v[216:231], v[28:31], v[64:67], v[216:231]
  ds_read_b64_tr_b16 v[24:25], v11 offset:36864
  ds_read_b64_tr_b16 v[26:27], v11 offset:37888
  v_mfma_f32_32x32x16_bf16 v[168:183], v[32:35], v[68:71], v[168:183]
  ds_read_b64_tr_b16 v[28:29], v12 offset:36864
  ds_read_b64_tr_b16 v[30:31], v12 offset:37888
  v_mfma_f32_32x32x16_bf16 v[184:199], v[36:39], v[68:71], v[184:199]
  ds_read_b64_tr_b16 v[32:33], v11 offset:37376
  ds_read_b64_tr_b16 v[34:35], v11 offset:38400
  v_mfma_f32_32x32x16_bf16 v[200:215], v[232:235], v[68:71], v[200:215]
  ds_read_b64_tr_b16 v[36:37], v12 offset:37376
  ds_read_b64_tr_b16 v[38:39], v12 offset:38400
  v_mfma_f32_32x32x16_bf16 v[216:231], v[236:239], v[68:71], v[216:231]
  ds_read_b64_tr_b16 v[232:233], v11 offset:40960
  ds_read_b64_tr_b16 v[234:235], v11 offset:41984
  s_waitcnt lgkmcnt(15)
  v_mfma_f32_32x32x16_bf16 v[104:119], v[240:243], v[40:43], v[104:119]
  ds_read_b64_tr_b16 v[236:237], v12 offset:40960
  ds_read_b64_tr_b16 v[238:239], v12 offset:41984
  s_waitcnt lgkmcnt(15)
  v_mfma_f32_32x32x16_bf16 v[120:135], v[244:247], v[40:43], v[120:135]
  ds_read_b64_tr_b16 v[240:241], v11 offset:41472
  ds_read_b64_tr_b16 v[242:243], v11 offset:42496
  s_waitcnt lgkmcnt(15)
  v_mfma_f32_32x32x16_bf16 v[136:151], v[16:19], v[40:43], v[136:151]
  ds_read_b64_tr_b16 v[244:245], v12 offset:41472
  ds_read_b64_tr_b16 v[246:247], v12 offset:42496
  s_waitcnt lgkmcnt(15)
  v_mfma_f32_32x32x16_bf16 v[152:167], v[20:23], v[40:43], v[152:167]
  ds_read_b64_tr_b16 v[16:17], v11 offset:45056
  ds_read_b64_tr_b16 v[18:19], v11 offset:46080
  s_waitcnt lgkmcnt(15)
  v_mfma_f32_32x32x16_bf16 v[104:119], v[24:27], v[44:47], v[104:119]
  ds_read_b64_tr_b16 v[20:21], v12 offset:45056
  ds_read_b64_tr_b16 v[22:23], v12 offset:46080
  s_waitcnt lgkmcnt(15)
  v_mfma_f32_32x32x16_bf16 v[120:135], v[28:31], v[44:47], v[120:135]
  ds_read_b64_tr_b16 v[24:25], v11 offset:45568
  ds_read_b64_tr_b16 v[26:27], v11 offset:46592
  s_waitcnt lgkmcnt(15)
  v_mfma_f32_32x32x16_bf16 v[136:151], v[32:35], v[44:47], v[136:151]
  ds_read_b64_tr_b16 v[28:29], v12 offset:45568
  ds_read_b64_tr_b16 v[30:31], v12 offset:46592
  s_waitcnt lgkmcnt(15)
  v_mfma_f32_32x32x16_bf16 v[152:167], v[36:39], v[44:47], v[152:167]
  s_waitcnt lgkmcnt(14)
  v_mfma_f32_32x32x16_bf16 v[104:119], v[232:235], v[48:51], v[104:119]
  s_waitcnt lgkmcnt(0)
  s_barrier
  v_mfma_f32_32x32x16_bf16 v[120:135], v[236:239], v[48:51], v[120:135]
  v_subrev_u32 v11, 65536, v11
  v_subrev_u32 v12, 65536, v12
  ds_read_b64_tr_b16 v[32:33], v11 offset:0
  ds_read_b64_tr_b16 v[34:35], v11 offset:1024
  ds_read_b64_tr_b16 v[36:37], v12 offset:0
  ds_read_b64_tr_b16 v[38:39], v12 offset:1024
  v_mfma_f32_32x32x16_bf16 v[136:151], v[240:243], v[48:51], v[136:151]
  ds_read_b64_tr_b16 v[232:233], v11 offset:512
  ds_read_b64_tr_b16 v[234:235], v11 offset:1536
  ds_read_b64_tr_b16 v[236:237], v12 offset:512
  ds_read_b64_tr_b16 v[238:239], v12 offset:1536
  v_mfma_f32_32x32x16_bf16 v[152:167], v[244:247], v[48:51], v[152:167]
  ds_read_b64_tr_b16 v[240:241], v11 offset:4096
  ds_read_b64_tr_b16 v[242:243], v11 offset:5120
  v_mfma_f32_32x32x16_bf16 v[104:119], v[16:19], v[52:55], v[104:119]
  ds_read_b64_tr_b16 v[244:245], v12 offset:4096
  ds_read_b64_tr_b16 v[246:247], v12 offset:5120
  v_mfma_f32_32x32x16_bf16 v[120:135], v[20:23], v[52:55], v[120:135]
  ds_read_b64_tr_b16 v[16:17], v11 offset:4608
  ds_read_b64_tr_b16 v[18:19], v11 offset:5632
  v_mfma_f32_32x32x16_bf16 v[136:151], v[24:27], v[52:55], v[136:151]
  ds_read_b64_tr_b16 v[20:21], v12 offset:4608
  ds_read_b64_tr_b16 v[22:23], v12 offset:5632
  v_mfma_f32_32x32x16_bf16 v[152:167], v[28:31], v[52:55], v[152:167]
  ds_read_b64_tr_b16 v[24:25], v11 offset:8192
  ds_read_b64_tr_b16 v[26:27], v11 offset:9216
  s_waitcnt lgkmcnt(15)
  v_mfma_f32_32x32x16_bf16 v[168:183], v[32:35], v[40:43], v[168:183]
  ds_read_b64_tr_b16 v[28:29], v12 offset:8192
  ds_read_b64_tr_b16 v[30:31], v12 offset:9216
  s_waitcnt lgkmcnt(15)
  v_mfma_f32_32x32x16_bf16 v[184:199], v[36:39], v[40:43], v[184:199]
  ds_read_b64_tr_b16 v[32:33], v11 offset:8704
  ds_read_b64_tr_b16 v[34:35], v11 offset:9728
  s_waitcnt lgkmcnt(15)
  v_mfma_f32_32x32x16_bf16 v[200:215], v[232:235], v[40:43], v[200:215]
  ds_read_b64_tr_b16 v[36:37], v12 offset:8704
  ds_read_b64_tr_b16 v[38:39], v12 offset:9728
  s_waitcnt lgkmcnt(15)
  v_mfma_f32_32x32x16_bf16 v[216:231], v[236:239], v[40:43], v[216:231]
  ds_read_b64_tr_b16 v[232:233], v11 offset:12288
  ds_read_b64_tr_b16 v[234:235], v11 offset:13312
  s_waitcnt lgkmcnt(15)
  v_mfma_f32_32x32x16_bf16 v[168:183], v[240:243], v[44:47], v[168:183]
  ds_read_b64_tr_b16 v[236:237], v12 offset:12288
  ds_read_b64_tr_b16 v[238:239], v12 offset:13312
  s_waitcnt lgkmcnt(15)
  v_mfma_f32_32x32x16_bf16 v[184:199], v[244:247], v[44:47], v[184:199]
  ds_read_b64_tr_b16 v[240:241], v11 offset:12800
  ds_read_b64_tr_b16 v[242:243], v11 offset:13824
  s_waitcnt lgkmcnt(15)
  v_mfma_f32_32x32x16_bf16 v[200:215], v[16:19], v[44:47], v[200:215]
  ds_read_b64_tr_b16 v[244:245], v12 offset:12800
  ds_read_b64_tr_b16 v[246:247], v12 offset:13824
  s_waitcnt lgkmcnt(15)
  v_mfma_f32_32x32x16_bf16 v[216:231], v[20:23], v[44:47], v[216:231]
  s_waitcnt lgkmcnt(14)
  v_mfma_f32_32x32x16_bf16 v[168:183], v[24:27], v[48:51], v[168:183]
  s_waitcnt lgkmcnt(0)
  s_barrier
  v_subrev_u32 v250, 65536, v250
  v_subrev_u32 v251, 65536, v251
  v_subrev_u32 v252, 65536, v252
  v_subrev_u32 v253, 65536, v253
  ds_read_b128 v[56:59], v250 offset:16384
  ds_read_b128 v[60:63], v251 offset:16384
  ds_read_b128 v[64:67], v252 offset:16384
  ds_read_b128 v[68:71], v253 offset:16384
  v_mfma_f32_32x32x16_bf16 v[184:199], v[28:31], v[48:51], v[184:199]
  ds_read_b64_tr_b16 v[16:17], v11 offset:32768
  ds_read_b64_tr_b16 v[18:19], v11 offset:33792
  ds_read_b64_tr_b16 v[20:21], v12 offset:32768
  ds_read_b64_tr_b16 v[22:23], v12 offset:33792
  v_mfma_f32_32x32x16_bf16 v[200:215], v[32:35], v[48:51], v[200:215]
  ds_read_b64_tr_b16 v[24:25], v11 offset:33280
  ds_read_b64_tr_b16 v[26:27], v11 offset:34304
  ds_read_b64_tr_b16 v[28:29], v12 offset:33280
  ds_read_b64_tr_b16 v[30:31], v12 offset:34304
  v_mfma_f32_32x32x16_bf16 v[216:231], v[36:39], v[48:51], v[216:231]
  ds_read_b64_tr_b16 v[32:33], v11 offset:36864
  ds_read_b64_tr_b16 v[34:35], v11 offset:37888
  v_mfma_f32_32x32x16_bf16 v[168:183], v[232:235], v[52:55], v[168:183]
  ds_read_b64_tr_b16 v[36:37], v12 offset:36864
  ds_read_b64_tr_b16 v[38:39], v12 offset:37888
  v_mfma_f32_32x32x16_bf16 v[184:199], v[236:239], v[52:55], v[184:199]
  ds_read_b64_tr_b16 v[232:233], v11 offset:37376
  ds_read_b64_tr_b16 v[234:235], v11 offset:38400
  v_mfma_f32_32x32x16_bf16 v[200:215], v[240:243], v[52:55], v[200:215]
  ds_read_b64_tr_b16 v[236:237], v12 offset:37376
  ds_read_b64_tr_b16 v[238:239], v12 offset:38400
  v_mfma_f32_32x32x16_bf16 v[216:231], v[244:247], v[52:55], v[216:231]
  ds_read_b64_tr_b16 v[240:241], v11 offset:40960
  ds_read_b64_tr_b16 v[242:243], v11 offset:41984
  s_waitcnt lgkmcnt(15)
  v_mfma_f32_32x32x16_bf16 v[104:119], v[16:19], v[56:59], v[104:119]
  ds_read_b64_tr_b16 v[244:245], v12 offset:40960
  ds_read_b64_tr_b16 v[246:247], v12 offset:41984
  s_waitcnt lgkmcnt(15)
  v_mfma_f32_32x32x16_bf16 v[120:135], v[20:23], v[56:59], v[120:135]
  ds_read_b64_tr_b16 v[16:17], v11 offset:41472
  ds_read_b64_tr_b16 v[18:19], v11 offset:42496
  s_waitcnt lgkmcnt(15)
  v_mfma_f32_32x32x16_bf16 v[136:151], v[24:27], v[56:59], v[136:151]
  ds_read_b64_tr_b16 v[20:21], v12 offset:41472
  ds_read_b64_tr_b16 v[22:23], v12 offset:42496
  s_waitcnt lgkmcnt(15)
  v_mfma_f32_32x32x16_bf16 v[152:167], v[28:31], v[56:59], v[152:167]
  ds_read_b64_tr_b16 v[24:25], v11 offset:45056
  ds_read_b64_tr_b16 v[26:27], v11 offset:46080
  s_waitcnt lgkmcnt(15)
  v_mfma_f32_32x32x16_bf16 v[104:119], v[32:35], v[60:63], v[104:119]
  ds_read_b64_tr_b16 v[28:29], v12 offset:45056
  ds_read_b64_tr_b16 v[30:31], v12 offset:46080
  s_waitcnt lgkmcnt(15)
  v_mfma_f32_32x32x16_bf16 v[120:135], v[36:39], v[60:63], v[120:135]
  ds_read_b64_tr_b16 v[32:33], v11 offset:45568
  ds_read_b64_tr_b16 v[34:35], v11 offset:46592
  s_waitcnt lgkmcnt(15)
  v_mfma_f32_32x32x16_bf16 v[136:151], v[232:235], v[60:63], v[136:151]
  ds_read_b64_tr_b16 v[36:37], v12 offset:45568
  ds_read_b64_tr_b16 v[38:39], v12 offset:46592
  s_waitcnt lgkmcnt(15)
  v_mfma_f32_32x32x16_bf16 v[152:167], v[236:239], v[60:63], v[152:167]
  s_waitcnt lgkmcnt(14)
  v_mfma_f32_32x32x16_bf16 v[104:119], v[240:243], v[64:67], v[104:119]
  s_waitcnt lgkmcnt(0)
  s_barrier
  v_mfma_f32_32x32x16_bf16 v[120:135], v[244:247], v[64:67], v[120:135]
  ds_read_b64_tr_b16 v[232:233], v11 offset:49152
  ds_read_b64_tr_b16 v[234:235], v11 offset:50176
  ds_read_b64_tr_b16 v[236:237], v12 offset:49152
  ds_read_b64_tr_b16 v[238:239], v12 offset:50176
  v_mfma_f32_32x32x16_bf16 v[136:151], v[16:19], v[64:67], v[136:151]
  ds_read_b64_tr_b16 v[240:241], v11 offset:49664
  ds_read_b64_tr_b16 v[242:243], v11 offset:50688
  ds_read_b64_tr_b16 v[244:245], v12 offset:49664
  ds_read_b64_tr_b16 v[246:247], v12 offset:50688
  v_mfma_f32_32x32x16_bf16 v[152:167], v[20:23], v[64:67], v[152:167]
  ds_read_b64_tr_b16 v[16:17], v11 offset:53248
  ds_read_b64_tr_b16 v[18:19], v11 offset:54272
  v_mfma_f32_32x32x16_bf16 v[104:119], v[24:27], v[68:71], v[104:119]
  ds_read_b64_tr_b16 v[20:21], v12 offset:53248
  ds_read_b64_tr_b16 v[22:23], v12 offset:54272
  v_mfma_f32_32x32x16_bf16 v[120:135], v[28:31], v[68:71], v[120:135]
  ds_read_b64_tr_b16 v[24:25], v11 offset:53760
  ds_read_b64_tr_b16 v[26:27], v11 offset:54784
  v_mfma_f32_32x32x16_bf16 v[136:151], v[32:35], v[68:71], v[136:151]
  ds_read_b64_tr_b16 v[28:29], v12 offset:53760
  ds_read_b64_tr_b16 v[30:31], v12 offset:54784
  v_mfma_f32_32x32x16_bf16 v[152:167], v[36:39], v[68:71], v[152:167]
  ds_read_b64_tr_b16 v[32:33], v11 offset:57344
  ds_read_b64_tr_b16 v[34:35], v11 offset:58368
  s_waitcnt lgkmcnt(15)
  v_mfma_f32_32x32x16_bf16 v[168:183], v[232:235], v[56:59], v[168:183]
  ds_read_b64_tr_b16 v[36:37], v12 offset:57344
  ds_read_b64_tr_b16 v[38:39], v12 offset:58368
  s_waitcnt lgkmcnt(15)
  v_mfma_f32_32x32x16_bf16 v[184:199], v[236:239], v[56:59], v[184:199]
  ds_read_b64_tr_b16 v[232:233], v11 offset:57856
  ds_read_b64_tr_b16 v[234:235], v11 offset:58880
  s_waitcnt lgkmcnt(15)
  v_mfma_f32_32x32x16_bf16 v[200:215], v[240:243], v[56:59], v[200:215]
  ds_read_b64_tr_b16 v[236:237], v12 offset:57856
  ds_read_b64_tr_b16 v[238:239], v12 offset:58880
  s_waitcnt lgkmcnt(15)
  v_mfma_f32_32x32x16_bf16 v[216:231], v[244:247], v[56:59], v[216:231]
  ds_read_b64_tr_b16 v[240:241], v11 offset:61440
  ds_read_b64_tr_b16 v[242:243], v11 offset:62464
  s_waitcnt lgkmcnt(15)
  v_mfma_f32_32x32x16_bf16 v[168:183], v[16:19], v[60:63], v[168:183]
  ds_read_b64_tr_b16 v[244:245], v12 offset:61440
  ds_read_b64_tr_b16 v[246:247], v12 offset:62464
  s_waitcnt lgkmcnt(15)
  v_mfma_f32_32x32x16_bf16 v[184:199], v[20:23], v[60:63], v[184:199]
  ds_read_b64_tr_b16 v[16:17], v11 offset:61952
  ds_read_b64_tr_b16 v[18:19], v11 offset:62976
  s_waitcnt lgkmcnt(15)
  v_mfma_f32_32x32x16_bf16 v[200:215], v[24:27], v[60:63], v[200:215]
  ds_read_b64_tr_b16 v[20:21], v12 offset:61952
  ds_read_b64_tr_b16 v[22:23], v12 offset:62976
  s_waitcnt lgkmcnt(15)
  v_mfma_f32_32x32x16_bf16 v[216:231], v[28:31], v[60:63], v[216:231]
  s_waitcnt lgkmcnt(14)
  v_mfma_f32_32x32x16_bf16 v[168:183], v[32:35], v[64:67], v[168:183]
  s_waitcnt lgkmcnt(0)
  s_barrier
  v_add_u32 v250, 65536, v250
  v_add_u32 v251, 65536, v251
  v_add_u32 v252, 65536, v252
  v_add_u32 v253, 65536, v253
  ds_read_b128 v[40:43], v250 offset:0
  ds_read_b128 v[44:47], v251 offset:0
  ds_read_b128 v[48:51], v252 offset:0
  ds_read_b128 v[52:55], v253 offset:0
  v_mfma_f32_32x32x16_bf16 v[184:199], v[36:39], v[64:67], v[184:199]
  v_add_u32 v11, 65536, v11
  v_add_u32 v12, 65536, v12
  ds_read_b64_tr_b16 v[24:25], v11 offset:16384
  ds_read_b64_tr_b16 v[26:27], v11 offset:17408
  ds_read_b64_tr_b16 v[28:29], v12 offset:16384
  ds_read_b64_tr_b16 v[30:31], v12 offset:17408
  v_mfma_f32_32x32x16_bf16 v[200:215], v[232:235], v[64:67], v[200:215]
  ds_read_b64_tr_b16 v[32:33], v11 offset:16896
  ds_read_b64_tr_b16 v[34:35], v11 offset:17920
  ds_read_b64_tr_b16 v[36:37], v12 offset:16896
  ds_read_b64_tr_b16 v[38:39], v12 offset:17920
  v_mfma_f32_32x32x16_bf16 v[216:231], v[236:239], v[64:67], v[216:231]
  ds_read_b64_tr_b16 v[232:233], v11 offset:20480
  ds_read_b64_tr_b16 v[234:235], v11 offset:21504
  v_mfma_f32_32x32x16_bf16 v[168:183], v[240:243], v[68:71], v[168:183]
  ds_read_b64_tr_b16 v[236:237], v12 offset:20480
  ds_read_b64_tr_b16 v[238:239], v12 offset:21504
  v_mfma_f32_32x32x16_bf16 v[184:199], v[244:247], v[68:71], v[184:199]
  ds_read_b64_tr_b16 v[240:241], v11 offset:20992
  ds_read_b64_tr_b16 v[242:243], v11 offset:22016
  v_mfma_f32_32x32x16_bf16 v[200:215], v[16:19], v[68:71], v[200:215]
  ds_read_b64_tr_b16 v[244:245], v12 offset:20992
  ds_read_b64_tr_b16 v[246:247], v12 offset:22016
  v_mfma_f32_32x32x16_bf16 v[216:231], v[20:23], v[68:71], v[216:231]
  ds_read_b64_tr_b16 v[16:17], v11 offset:24576
  ds_read_b64_tr_b16 v[18:19], v11 offset:25600
  s_waitcnt lgkmcnt(15)
  v_mfma_f32_32x32x16_bf16 v[104:119], v[24:27], v[40:43], v[104:119]
  ds_read_b64_tr_b16 v[20:21], v12 offset:24576
  ds_read_b64_tr_b16 v[22:23], v12 offset:25600
  s_waitcnt lgkmcnt(15)
  v_mfma_f32_32x32x16_bf16 v[120:135], v[28:31], v[40:43], v[120:135]
  ds_read_b64_tr_b16 v[24:25], v11 offset:25088
  ds_read_b64_tr_b16 v[26:27], v11 offset:26112
  s_waitcnt lgkmcnt(15)
  v_mfma_f32_32x32x16_bf16 v[136:151], v[32:35], v[40:43], v[136:151]
  ds_read_b64_tr_b16 v[28:29], v12 offset:25088
  ds_read_b64_tr_b16 v[30:31], v12 offset:26112
  s_waitcnt lgkmcnt(15)
  v_mfma_f32_32x32x16_bf16 v[152:167], v[36:39], v[40:43], v[152:167]
  ds_read_b64_tr_b16 v[32:33], v11 offset:28672
  ds_read_b64_tr_b16 v[34:35], v11 offset:29696
  s_waitcnt lgkmcnt(15)
  v_mfma_f32_32x32x16_bf16 v[104:119], v[232:235], v[44:47], v[104:119]
  ds_read_b64_tr_b16 v[36:37], v12 offset:28672
  ds_read_b64_tr_b16 v[38:39], v12 offset:29696
  s_waitcnt lgkmcnt(15)
  v_mfma_f32_32x32x16_bf16 v[120:135], v[236:239], v[44:47], v[120:135]
  ds_read_b64_tr_b16 v[232:233], v11 offset:29184
  ds_read_b64_tr_b16 v[234:235], v11 offset:30208
  s_waitcnt lgkmcnt(15)
  v_mfma_f32_32x32x16_bf16 v[136:151], v[240:243], v[44:47], v[136:151]
  ds_read_b64_tr_b16 v[236:237], v12 offset:29184
  ds_read_b64_tr_b16 v[238:239], v12 offset:30208
  s_waitcnt lgkmcnt(15)
  v_mfma_f32_32x32x16_bf16 v[152:167], v[244:247], v[44:47], v[152:167]
  s_waitcnt lgkmcnt(14)
  v_mfma_f32_32x32x16_bf16 v[104:119], v[16:19], v[48:51], v[104:119]
  s_waitcnt lgkmcnt(0)
  s_barrier
  v_mfma_f32_32x32x16_bf16 v[120:135], v[20:23], v[48:51], v[120:135]
  ds_read_b64_tr_b16 v[240:241], v11 offset:32768
  ds_read_b64_tr_b16 v[242:243], v11 offset:33792
  ds_read_b64_tr_b16 v[244:245], v12 offset:32768
  ds_read_b64_tr_b16 v[246:247], v12 offset:33792
  v_mfma_f32_32x32x16_bf16 v[136:151], v[24:27], v[48:51], v[136:151]
  ds_read_b64_tr_b16 v[16:17], v11 offset:33280
  ds_read_b64_tr_b16 v[18:19], v11 offset:34304
  ds_read_b64_tr_b16 v[20:21], v12 offset:33280
  ds_read_b64_tr_b16 v[22:23], v12 offset:34304
  v_mfma_f32_32x32x16_bf16 v[152:167], v[28:31], v[48:51], v[152:167]
  ds_read_b64_tr_b16 v[24:25], v11 offset:36864
  ds_read_b64_tr_b16 v[26:27], v11 offset:37888
  v_mfma_f32_32x32x16_bf16 v[104:119], v[32:35], v[52:55], v[104:119]
  ds_read_b64_tr_b16 v[28:29], v12 offset:36864
  ds_read_b64_tr_b16 v[30:31], v12 offset:37888
  v_mfma_f32_32x32x16_bf16 v[120:135], v[36:39], v[52:55], v[120:135]
  ds_read_b64_tr_b16 v[32:33], v11 offset:37376
  ds_read_b64_tr_b16 v[34:35], v11 offset:38400
  v_mfma_f32_32x32x16_bf16 v[136:151], v[232:235], v[52:55], v[136:151]
  ds_read_b64_tr_b16 v[36:37], v12 offset:37376
  ds_read_b64_tr_b16 v[38:39], v12 offset:38400
  v_mfma_f32_32x32x16_bf16 v[152:167], v[236:239], v[52:55], v[152:167]
  ds_read_b64_tr_b16 v[232:233], v11 offset:40960
  ds_read_b64_tr_b16 v[234:235], v11 offset:41984
  s_waitcnt lgkmcnt(15)
  v_mfma_f32_32x32x16_bf16 v[168:183], v[240:243], v[40:43], v[168:183]
  ds_read_b64_tr_b16 v[236:237], v12 offset:40960
  ds_read_b64_tr_b16 v[238:239], v12 offset:41984
  s_waitcnt lgkmcnt(15)
  v_mfma_f32_32x32x16_bf16 v[184:199], v[244:247], v[40:43], v[184:199]
  ds_read_b64_tr_b16 v[240:241], v11 offset:41472
  ds_read_b64_tr_b16 v[242:243], v11 offset:42496
  s_waitcnt lgkmcnt(15)
  v_mfma_f32_32x32x16_bf16 v[200:215], v[16:19], v[40:43], v[200:215]
  ds_read_b64_tr_b16 v[244:245], v12 offset:41472
  ds_read_b64_tr_b16 v[246:247], v12 offset:42496
  s_waitcnt lgkmcnt(15)
  v_mfma_f32_32x32x16_bf16 v[216:231], v[20:23], v[40:43], v[216:231]
  ds_read_b64_tr_b16 v[16:17], v11 offset:45056
  ds_read_b64_tr_b16 v[18:19], v11 offset:46080
  s_waitcnt lgkmcnt(15)
  v_mfma_f32_32x32x16_bf16 v[168:183], v[24:27], v[44:47], v[168:183]
  ds_read_b64_tr_b16 v[20:21], v12 offset:45056
  ds_read_b64_tr_b16 v[22:23], v12 offset:46080
  s_waitcnt lgkmcnt(15)
  v_mfma_f32_32x32x16_bf16 v[184:199], v[28:31], v[44:47], v[184:199]
  ds_read_b64_tr_b16 v[24:25], v11 offset:45568
  ds_read_b64_tr_b16 v[26:27], v11 offset:46592
  s_waitcnt lgkmcnt(15)
  v_mfma_f32_32x32x16_bf16 v[200:215], v[32:35], v[44:47], v[200:215]
  ds_read_b64_tr_b16 v[28:29], v12 offset:45568
  ds_read_b64_tr_b16 v[30:31], v12 offset:46592
  s_waitcnt lgkmcnt(15)
  v_mfma_f32_32x32x16_bf16 v[216:231], v[36:39], v[44:47], v[216:231]
  s_waitcnt lgkmcnt(14)
  v_mfma_f32_32x32x16_bf16 v[168:183], v[232:235], v[48:51], v[168:183]
  s_waitcnt lgkmcnt(0)
  s_barrier
  v_subrev_u32 v250, 65536, v250
  v_subrev_u32 v251, 65536, v251
  v_subrev_u32 v252, 65536, v252
  v_subrev_u32 v253, 65536, v253
  ds_read_b128 v[56:59], v250 offset:0
  ds_read_b128 v[60:63], v251 offset:0
  ds_read_b128 v[64:67], v252 offset:0
  ds_read_b128 v[68:71], v253 offset:0
  v_mfma_f32_32x32x16_bf16 v[184:199], v[236:239], v[48:51], v[184:199]
  v_subrev_u32 v11, 65536, v11
  v_subrev_u32 v12, 65536, v12
  ds_read_b64_tr_b16 v[32:33], v11 offset:16384
  ds_read_b64_tr_b16 v[34:35], v11 offset:17408
  ds_read_b64_tr_b16 v[36:37], v12 offset:16384
  ds_read_b64_tr_b16 v[38:39], v12 offset:17408
  v_mfma_f32_32x32x16_bf16 v[200:215], v[240:243], v[48:51], v[200:215]
  ds_read_b64_tr_b16 v[232:233], v11 offset:16896
  ds_read_b64_tr_b16 v[234:235], v11 offset:17920
  ds_read_b64_tr_b16 v[236:237], v12 offset:16896
  ds_read_b64_tr_b16 v[238:239], v12 offset:17920
  v_mfma_f32_32x32x16_bf16 v[216:231], v[244:247], v[48:51], v[216:231]
  ds_read_b64_tr_b16 v[240:241], v11 offset:20480
  ds_read_b64_tr_b16 v[242:243], v11 offset:21504
  v_mfma_f32_32x32x16_bf16 v[168:183], v[16:19], v[52:55], v[168:183]
  ds_read_b64_tr_b16 v[244:245], v12 offset:20480
  ds_read_b64_tr_b16 v[246:247], v12 offset:21504
  v_mfma_f32_32x32x16_bf16 v[184:199], v[20:23], v[52:55], v[184:199]
  ds_read_b64_tr_b16 v[16:17], v11 offset:20992
  ds_read_b64_tr_b16 v[18:19], v11 offset:22016
  v_mfma_f32_32x32x16_bf16 v[200:215], v[24:27], v[52:55], v[200:215]
  ds_read_b64_tr_b16 v[20:21], v12 offset:20992
  ds_read_b64_tr_b16 v[22:23], v12 offset:22016
  v_mfma_f32_32x32x16_bf16 v[216:231], v[28:31], v[52:55], v[216:231]
  ds_read_b64_tr_b16 v[24:25], v11 offset:24576
  ds_read_b64_tr_b16 v[26:27], v11 offset:25600
  s_waitcnt lgkmcnt(15)
  v_mfma_f32_32x32x16_bf16 v[104:119], v[32:35], v[56:59], v[104:119]
  ds_read_b64_tr_b16 v[28:29], v12 offset:24576
  ds_read_b64_tr_b16 v[30:31], v12 offset:25600
  s_waitcnt lgkmcnt(15)
  v_mfma_f32_32x32x16_bf16 v[120:135], v[36:39], v[56:59], v[120:135]
  ds_read_b64_tr_b16 v[32:33], v11 offset:25088
  ds_read_b64_tr_b16 v[34:35], v11 offset:26112
  s_waitcnt lgkmcnt(15)
  v_mfma_f32_32x32x16_bf16 v[136:151], v[232:235], v[56:59], v[136:151]
  ds_read_b64_tr_b16 v[36:37], v12 offset:25088
  ds_read_b64_tr_b16 v[38:39], v12 offset:26112
  s_waitcnt lgkmcnt(15)
  v_mfma_f32_32x32x16_bf16 v[152:167], v[236:239], v[56:59], v[152:167]
  ds_read_b64_tr_b16 v[232:233], v11 offset:28672
  ds_read_b64_tr_b16 v[234:235], v11 offset:29696
  s_waitcnt lgkmcnt(15)
  v_mfma_f32_32x32x16_bf16 v[104:119], v[240:243], v[60:63], v[104:119]
  ds_read_b64_tr_b16 v[236:237], v12 offset:28672
  ds_read_b64_tr_b16 v[238:239], v12 offset:29696
  s_waitcnt lgkmcnt(15)
  v_mfma_f32_32x32x16_bf16 v[120:135], v[244:247], v[60:63], v[120:135]
  ds_read_b64_tr_b16 v[240:241], v11 offset:29184
  ds_read_b64_tr_b16 v[242:243], v11 offset:30208
  s_waitcnt lgkmcnt(15)
  v_mfma_f32_32x32x16_bf16 v[136:151], v[16:19], v[60:63], v[136:151]
  ds_read_b64_tr_b16 v[244:245], v12 offset:29184
  ds_read_b64_tr_b16 v[246:247], v12 offset:30208
  s_waitcnt lgkmcnt(15)
  v_mfma_f32_32x32x16_bf16 v[152:167], v[20:23], v[60:63], v[152:167]
  s_waitcnt lgkmcnt(14)
  v_mfma_f32_32x32x16_bf16 v[104:119], v[24:27], v[64:67], v[104:119]
  s_waitcnt lgkmcnt(0)
  s_barrier
  v_mfma_f32_32x32x16_bf16 v[120:135], v[28:31], v[64:67], v[120:135]
  ds_read_b64_tr_b16 v[16:17], v11 offset:32768
  ds_read_b64_tr_b16 v[18:19], v11 offset:33792
  ds_read_b64_tr_b16 v[20:21], v12 offset:32768
  ds_read_b64_tr_b16 v[22:23], v12 offset:33792
  v_mfma_f32_32x32x16_bf16 v[136:151], v[32:35], v[64:67], v[136:151]
  ds_read_b64_tr_b16 v[24:25], v11 offset:33280
  ds_read_b64_tr_b16 v[26:27], v11 offset:34304
  ds_read_b64_tr_b16 v[28:29], v12 offset:33280
  ds_read_b64_tr_b16 v[30:31], v12 offset:34304
  v_mfma_f32_32x32x16_bf16 v[152:167], v[36:39], v[64:67], v[152:167]
  ds_read_b64_tr_b16 v[32:33], v11 offset:36864
  ds_read_b64_tr_b16 v[34:35], v11 offset:37888
  v_mfma_f32_32x32x16_bf16 v[104:119], v[232:235], v[68:71], v[104:119]
  ds_read_b64_tr_b16 v[36:37], v12 offset:36864
  ds_read_b64_tr_b16 v[38:39], v12 offset:37888
  v_mfma_f32_32x32x16_bf16 v[120:135], v[236:239], v[68:71], v[120:135]
  ds_read_b64_tr_b16 v[232:233], v11 offset:37376
  ds_read_b64_tr_b16 v[234:235], v11 offset:38400
  v_mfma_f32_32x32x16_bf16 v[136:151], v[240:243], v[68:71], v[136:151]
  ds_read_b64_tr_b16 v[236:237], v12 offset:37376
  ds_read_b64_tr_b16 v[238:239], v12 offset:38400
  v_mfma_f32_32x32x16_bf16 v[152:167], v[244:247], v[68:71], v[152:167]
  ds_read_b64_tr_b16 v[240:241], v11 offset:40960
  ds_read_b64_tr_b16 v[242:243], v11 offset:41984
  s_waitcnt lgkmcnt(15)
  v_mfma_f32_32x32x16_bf16 v[168:183], v[16:19], v[56:59], v[168:183]
  ds_read_b64_tr_b16 v[244:245], v12 offset:40960
  ds_read_b64_tr_b16 v[246:247], v12 offset:41984
  s_waitcnt lgkmcnt(15)
  v_mfma_f32_32x32x16_bf16 v[184:199], v[20:23], v[56:59], v[184:199]
  ds_read_b64_tr_b16 v[16:17], v11 offset:41472
  ds_read_b64_tr_b16 v[18:19], v11 offset:42496
  s_waitcnt lgkmcnt(15)
  v_mfma_f32_32x32x16_bf16 v[200:215], v[24:27], v[56:59], v[200:215]
  ds_read_b64_tr_b16 v[20:21], v12 offset:41472
  ds_read_b64_tr_b16 v[22:23], v12 offset:42496
  s_waitcnt lgkmcnt(15)
  v_mfma_f32_32x32x16_bf16 v[216:231], v[28:31], v[56:59], v[216:231]
  ds_read_b64_tr_b16 v[24:25], v11 offset:45056
  ds_read_b64_tr_b16 v[26:27], v11 offset:46080
  v_mul_f32 v104, s66, v104
  v_mul_f32 v105, s66, v105
  v_mul_f32 v106, s66, v106
  v_mul_f32 v107, s66, v107
  v_mul_f32 v108, s66, v108
  v_mul_f32 v109, s66, v109
  v_mul_f32 v110, s66, v110
  v_mul_f32 v111, s66, v111
  s_waitcnt lgkmcnt(15)
  v_mfma_f32_32x32x16_bf16 v[168:183], v[32:35], v[60:63], v[168:183]
  ds_read_b64_tr_b16 v[28:29], v12 offset:45056
  ds_read_b64_tr_b16 v[30:31], v12 offset:46080
  v_mul_f32 v112, s66, v112
  v_mul_f32 v113, s66, v113
  v_mul_f32 v114, s66, v114
  v_mul_f32 v115, s66, v115
  v_mul_f32 v116, s66, v116
  v_mul_f32 v117, s66, v117
  v_mul_f32 v118, s66, v118
  v_mul_f32 v119, s66, v119
  s_waitcnt lgkmcnt(15)
  v_mfma_f32_32x32x16_bf16 v[184:199], v[36:39], v[60:63], v[184:199]
  ds_read_b64_tr_b16 v[32:33], v11 offset:45568
  ds_read_b64_tr_b16 v[34:35], v11 offset:46592
  v_cvt_pk_bf16_f32 v72, v104, v105
  v_cvt_pk_bf16_f32 v73, v106, v107
  v_cvt_pk_bf16_f32 v74, v108, v109
  v_cvt_pk_bf16_f32 v75, v110, v111
  v_cvt_pk_bf16_f32 v76, v112, v113
  v_cvt_pk_bf16_f32 v77, v114, v115
  v_cvt_pk_bf16_f32 v78, v116, v117
  v_cvt_pk_bf16_f32 v79, v118, v119
  s_waitcnt lgkmcnt(15)
  v_mfma_f32_32x32x16_bf16 v[200:215], v[232:235], v[60:63], v[200:215]
  ds_read_b64_tr_b16 v[36:37], v12 offset:45568
  ds_read_b64_tr_b16 v[38:39], v12 offset:46592
  v_mul_f32 v120, s66, v120
  v_mul_f32 v121, s66, v121
  v_mul_f32 v122, s66, v122
  v_mul_f32 v123, s66, v123
  v_mul_f32 v124, s66, v124
  v_mul_f32 v125, s66, v125
  v_mul_f32 v126, s66, v126
  v_mul_f32 v127, s66, v127
  s_waitcnt lgkmcnt(15)
  v_mfma_f32_32x32x16_bf16 v[216:231], v[236:239], v[60:63], v[216:231]
  v_mul_f32 v128, s66, v128
  v_mul_f32 v129, s66, v129
  v_mul_f32 v130, s66, v130
  v_mul_f32 v131, s66, v131
  v_mul_f32 v132, s66, v132
  v_mul_f32 v133, s66, v133
  v_mul_f32 v134, s66, v134
  v_mul_f32 v135, s66, v135
  s_waitcnt lgkmcnt(14)
  v_mfma_f32_32x32x16_bf16 v[168:183], v[240:243], v[64:67], v[168:183]
  v_cvt_pk_bf16_f32 v80, v120, v121
  v_cvt_pk_bf16_f32 v81, v122, v123
  v_cvt_pk_bf16_f32 v82, v124, v125
  v_cvt_pk_bf16_f32 v83, v126, v127
  v_cvt_pk_bf16_f32 v84, v128, v129
  v_cvt_pk_bf16_f32 v85, v130, v131
  v_cvt_pk_bf16_f32 v86, v132, v133
  v_cvt_pk_bf16_f32 v87, v134, v135
  s_waitcnt lgkmcnt(12)
  v_mfma_f32_32x32x16_bf16 v[184:199], v[244:247], v[64:67], v[184:199]
  v_mul_f32 v136, s66, v136
  v_mul_f32 v137, s66, v137
  v_mul_f32 v138, s66, v138
  v_mul_f32 v139, s66, v139
  v_mul_f32 v140, s66, v140
  v_mul_f32 v141, s66, v141
  v_mul_f32 v142, s66, v142
  v_mul_f32 v143, s66, v143
  s_waitcnt lgkmcnt(10)
  v_mfma_f32_32x32x16_bf16 v[200:215], v[16:19], v[64:67], v[200:215]
  v_mul_f32 v144, s66, v144
  v_mul_f32 v145, s66, v145
  v_mul_f32 v146, s66, v146
  v_mul_f32 v147, s66, v147
  v_mul_f32 v148, s66, v148
  v_mul_f32 v149, s66, v149
  v_mul_f32 v150, s66, v150
  v_mul_f32 v151, s66, v151
  s_waitcnt lgkmcnt(8)
  v_mfma_f32_32x32x16_bf16 v[216:231], v[20:23], v[64:67], v[216:231]
  v_cvt_pk_bf16_f32 v88, v136, v137
  v_cvt_pk_bf16_f32 v89, v138, v139
  v_cvt_pk_bf16_f32 v90, v140, v141
  v_cvt_pk_bf16_f32 v91, v142, v143
  v_cvt_pk_bf16_f32 v92, v144, v145
  v_cvt_pk_bf16_f32 v93, v146, v147
  v_cvt_pk_bf16_f32 v94, v148, v149
  v_cvt_pk_bf16_f32 v95, v150, v151
  s_waitcnt lgkmcnt(6)
  v_mfma_f32_32x32x16_bf16 v[168:183], v[24:27], v[68:71], v[168:183]
  v_mul_f32 v152, s66, v152
  v_mul_f32 v153, s66, v153
  v_mul_f32 v154, s66, v154
  v_mul_f32 v155, s66, v155
  v_mul_f32 v156, s66, v156
  v_mul_f32 v157, s66, v157
  v_mul_f32 v158, s66, v158
  v_mul_f32 v159, s66, v159
  s_waitcnt lgkmcnt(4)
  v_mfma_f32_32x32x16_bf16 v[184:199], v[28:31], v[68:71], v[184:199]
  v_mul_f32 v160, s66, v160
  v_mul_f32 v161, s66, v161
  v_mul_f32 v162, s66, v162
  v_mul_f32 v163, s66, v163
  v_mul_f32 v164, s66, v164
  v_mul_f32 v165, s66, v165
  v_mul_f32 v166, s66, v166
  v_mul_f32 v167, s66, v167
  s_waitcnt lgkmcnt(2)
  v_mfma_f32_32x32x16_bf16 v[200:215], v[32:35], v[68:71], v[200:215]
  v_cvt_pk_bf16_f32 v96, v152, v153
  v_cvt_pk_bf16_f32 v97, v154, v155
  v_cvt_pk_bf16_f32 v98, v156, v157
  v_cvt_pk_bf16_f32 v99, v158, v159
  v_cvt_pk_bf16_f32 v100, v160, v161
  v_cvt_pk_bf16_f32 v101, v162, v163
  v_cvt_pk_bf16_f32 v102, v164, v165
  v_cvt_pk_bf16_f32 v103, v166, v167
  s_waitcnt lgkmcnt(0)
  v_mfma_f32_32x32x16_bf16 v[216:231], v[36:39], v[68:71], v[216:231]
  s_barrier
  v_add_u32 v2, 65536, v2
  v_add_u32 v3, 65536, v3
  v_add_u32 v4, 65536, v4
  v_add_u32 v5, 65536, v5
  ds_read_b128 v[16:19], v2 offset:49152
  ds_read_b128 v[20:23], v3 offset:49152
  ds_read_b128 v[24:27], v4 offset:49152
  ds_read_b128 v[28:31], v5 offset:49152
  ds_read_b128 v[32:35], v2 offset:49664
  ds_read_b128 v[36:39], v3 offset:49664
  s_waitcnt lgkmcnt(5)
  v_mfma_f32_32x32x16_bf16 v[40:55], v[16:19], v[72:75], 0
  ds_read_b128 v[16:19], v4 offset:49664
  v_mul_f32 v168, s66, v168
  v_mul_f32 v169, s66, v169
  v_mul_f32 v170, s66, v170
  v_mul_f32 v171, s66, v171
  v_mul_f32 v172, s66, v172
  v_mul_f32 v173, s66, v173
  v_mul_f32 v174, s66, v174
  v_mul_f32 v175, s66, v175
  v_mul_f32 v176, s66, v176
  v_mul_f32 v177, s66, v177
  v_mul_f32 v178, s66, v178
  v_mul_f32 v179, s66, v179
  s_waitcnt lgkmcnt(5)
  v_mfma_f32_32x32x16_bf16 v[40:55], v[20:23], v[76:79], v[40:55]
  ds_read_b128 v[20:23], v5 offset:49664
  v_mul_f32 v180, s66, v180
  v_mul_f32 v181, s66, v181
  v_mul_f32 v182, s66, v182
  v_mul_f32 v183, s66, v183
  v_cvt_pk_bf16_f32 v168, v168, v169
  v_cvt_pk_bf16_f32 v169, v170, v171
  v_cvt_pk_bf16_f32 v170, v172, v173
  v_cvt_pk_bf16_f32 v171, v174, v175
  v_cvt_pk_bf16_f32 v172, v176, v177
  v_cvt_pk_bf16_f32 v173, v178, v179
  v_cvt_pk_bf16_f32 v174, v180, v181
  v_cvt_pk_bf16_f32 v175, v182, v183
  s_waitcnt lgkmcnt(5)
  v_mfma_f32_32x32x16_bf16 v[40:55], v[24:27], v[80:83], v[40:55]
  ds_read_b128 v[24:27], v2 offset:57344
  v_mul_f32 v184, s66, v184
  v_mul_f32 v185, s66, v185
  v_mul_f32 v186, s66, v186
  v_mul_f32 v187, s66, v187
  v_mul_f32 v188, s66, v188
  v_mul_f32 v189, s66, v189
  v_mul_f32 v190, s66, v190
  v_mul_f32 v191, s66, v191
  v_mul_f32 v192, s66, v192
  v_mul_f32 v193, s66, v193
  v_mul_f32 v194, s66, v194
  v_mul_f32 v195, s66, v195
  s_waitcnt lgkmcnt(5)
  v_mfma_f32_32x32x16_bf16 v[40:55], v[28:31], v[84:87], v[40:55]
  ds_read_b128 v[28:31], v3 offset:57344
  v_mul_f32 v196, s66, v196
  v_mul_f32 v197, s66, v197
  v_mul_f32 v198, s66, v198
  v_mul_f32 v199, s66, v199
  v_cvt_pk_bf16_f32 v176, v184, v185
  v_cvt_pk_bf16_f32 v177, v186, v187
  v_cvt_pk_bf16_f32 v178, v188, v189
  v_cvt_pk_bf16_f32 v179, v190, v191
  v_cvt_pk_bf16_f32 v180, v192, v193
  v_cvt_pk_bf16_f32 v181, v194, v195
  v_cvt_pk_bf16_f32 v182, v196, v197
  v_cvt_pk_bf16_f32 v183, v198, v199
  s_waitcnt lgkmcnt(5)
  v_mfma_f32_32x32x16_bf16 v[40:55], v[32:35], v[88:91], v[40:55]
  ds_read_b128 v[32:35], v4 offset:57344
  v_mul_f32 v200, s66, v200
  v_mul_f32 v201, s66, v201
  v_mul_f32 v202, s66, v202
  v_mul_f32 v203, s66, v203
  v_mul_f32 v204, s66, v204
  v_mul_f32 v205, s66, v205
  v_mul_f32 v206, s66, v206
  v_mul_f32 v207, s66, v207
  v_mul_f32 v208, s66, v208
  v_mul_f32 v209, s66, v209
  v_mul_f32 v210, s66, v210
  v_mul_f32 v211, s66, v211
  s_waitcnt lgkmcnt(5)
  v_mfma_f32_32x32x16_bf16 v[40:55], v[36:39], v[92:95], v[40:55]
  ds_read_b128 v[36:39], v5 offset:57344
  v_mul_f32 v212, s66, v212
  v_mul_f32 v213, s66, v213
  v_mul_f32 v214, s66, v214
  v_mul_f32 v215, s66, v215
  v_cvt_pk_bf16_f32 v184, v200, v201
  v_cvt_pk_bf16_f32 v185, v202, v203
  v_cvt_pk_bf16_f32 v186, v204, v205
  v_cvt_pk_bf16_f32 v187, v206, v207
  v_cvt_pk_bf16_f32 v188, v208, v209
  v_cvt_pk_bf16_f32 v189, v210, v211
  v_cvt_pk_bf16_f32 v190, v212, v213
  v_cvt_pk_bf16_f32 v191, v214, v215
  s_waitcnt lgkmcnt(5)
  v_mfma_f32_32x32x16_bf16 v[40:55], v[16:19], v[96:99], v[40:55]
  ds_read_b128 v[16:19], v2 offset:57856
  v_mul_f32 v216, s66, v216
  v_mul_f32 v217, s66, v217
  v_mul_f32 v218, s66, v218
  v_mul_f32 v219, s66, v219
  v_mul_f32 v220, s66, v220
  v_mul_f32 v221, s66, v221
  v_mul_f32 v222, s66, v222
  v_mul_f32 v223, s66, v223
  v_mul_f32 v224, s66, v224
  v_mul_f32 v225, s66, v225
  v_mul_f32 v226, s66, v226
  v_mul_f32 v227, s66, v227
  s_waitcnt lgkmcnt(5)
  v_mfma_f32_32x32x16_bf16 v[40:55], v[20:23], v[100:103], v[40:55]
  ds_read_b128 v[20:23], v3 offset:57856
  v_mul_f32 v228, s66, v228
  v_mul_f32 v229, s66, v229
  v_mul_f32 v230, s66, v230
  v_mul_f32 v231, s66, v231
  v_cvt_pk_bf16_f32 v192, v216, v217
  v_cvt_pk_bf16_f32 v193, v218, v219
  v_cvt_pk_bf16_f32 v194, v220, v221
  v_cvt_pk_bf16_f32 v195, v222, v223
  v_cvt_pk_bf16_f32 v196, v224, v225
  v_cvt_pk_bf16_f32 v197, v226, v227
  v_cvt_pk_bf16_f32 v198, v228, v229
  v_cvt_pk_bf16_f32 v199, v230, v231
  s_waitcnt lgkmcnt(0)
  s_nop 0
L_A_head:
  v_mov_b32 v9, 0
  v_mov_b32 v10, 0
  v_mov_b32 v8, 0
  s_mov_b32 s67, 0x42200000
  s_mov_b32 s44, 1
  v_max3_f32 v15, |v40|, |v41|, |v42|
  v_max3_f32 v1, |v43|, |v44|, |v45|
  v_max3_f32 v15, v15, |v46|, |v47|
  v_max3_f32 v1, v1, |v48|, |v49|
  v_max3_f32 v15, v15, |v50|, |v51|
  v_max3_f32 v1, v1, |v52|, |v53|
  v_max3_f32 v15, v15, |v54|, |v55|
  v_max_f32 v15, v15, v1
  v_cmp_nge_f32 vcc, s67, v15
  v_mfma_f32_32x32x16_bf16 v[56:71], v[24:27], v[72:75], 0
  s_cbranch_vccnz L_A_stub0
L_A_back0:
  s_mov_b32 s44, 0
  v_exp_f32 v40, v40
  ds_read_b128 v[200:203], v4 offset:57856
  ds_read_b128 v[204:207], v5 offset:57856
  v_exp_f32 v41, v41
  v_exp_f32 v42, v42
  v_add_f32 v9, v9, v40
  v_exp_f32 v43, v43
  v_mfma_f32_32x32x16_bf16 v[56:71], v[28:31], v[76:79], v[56:71]
  s_barrier
  v_add_u32 v6, 131072, v6
  v_add_u32 v7, 131072, v7
  ds_read_b64_tr_b16 v[24:25], v6 offset:0
  ds_read_b64_tr_b16 v[26:27], v6 offset:2048
  ds_read_b64_tr_b16 v[28:29], v7 offset:0
  ds_read_b64_tr_b16 v[30:31], v7 offset:2048
  v_add_f32 v10, v10, v41
  v_cvt_pk_bf16_f32 v40, v40, v41
  v_exp_f32 v44, v44
  v_add_f32 v9, v9, v42
  v_exp_f32 v45, v45
  v_mfma_f32_32x32x16_bf16 v[56:71], v[32:35], v[80:83], v[56:71]
  ds_read_b64_tr_b16 v[32:33], v6 offset:512
  ds_read_b64_tr_b16 v[34:35], v6 offset:2560
  v_add_f32 v10, v10, v43
  v_cvt_pk_bf16_f32 v41, v42, v43
  v_exp_f32 v46, v46
  v_add_f32 v9, v9, v44
  v_exp_f32 v47, v47
  v_mfma_f32_32x32x16_bf16 v[56:71], v[36:39], v[84:87], v[56:71]
  ds_read_b64_tr_b16 v[36:37], v7 offset:512
  ds_read_b64_tr_b16 v[38:39], v7 offset:2560
  v_add_f32 v10, v10, v45
  v_cvt_pk_bf16_f32 v42, v44, v45
  v_exp_f32 v48, v48
  v_add_f32 v9, v9, v46
  v_exp_f32 v49, v49
  v_mfma_f32_32x32x16_bf16 v[56:71], v[16:19], v[88:91], v[56:71]
  ds_read_b64_tr_b16 v[16:17], v6 offset:4096
  ds_read_b64_tr_b16 v[18:19], v6 offset:6144
  v_add_f32 v10, v10, v47
  v_cvt_pk_bf16_f32 v43, v46, v47
  v_exp_f32 v50, v50
  v_add_f32 v9, v9, v48
  v_exp_f32 v51, v51
  v_mfma_f32_32x32x16_bf16 v[56:71], v[20:23], v[92:95], v[56:71]
  ds_read_b64_tr_b16 v[20:21], v7 offset:4096
  ds_read_b64_tr_b16 v[22:23], v7 offset:6144
  v_add_f32 v10, v10, v49
  v_cvt_pk_bf16_f32 v44, v48, v49
  v_exp_f32 v52, v52
  v_add_f32 v9, v9, v50
  v_exp_f32 v53, v53
  s_waitcnt lgkmcnt(12)
  v_mfma_f32_32x32x16_bf16 v[56:71], v[200:203], v[96:99], v[56:71]
  ds_read_b64_tr_b16 v[200:201], v6 offset:4608
  ds_read_b64_tr_b16 v[202:203], v6 offset:6656
  v_add_f32 v10, v10, v51
  v_cvt_pk_bf16_f32 v45, v50, v51
  v_exp_f32 v54, v54
  v_add_f32 v9, v9, v52
  v_exp_f32 v55, v55
  v_mfma_f32_32x32x16_bf16 v[56:71], v[204:207], v[100:103], v[56:71]
  v_add_f32 v10, v10, v53
  v_cvt_pk_bf16_f32 v46, v52, v53
  v_add_f32 v9, v9, v54
  v_add_f32 v10, v10, v55
  v_cvt_pk_bf16_f32 v47, v54, v55
  s_waitcnt lgkmcnt(10)
  v_mfma_f32_32x32x16_bf16 v[104:119], v[24:27], v[40:43], 0
  ds_read_b64_tr_b16 v[204:205], v7 offset:4608
  ds_read_b64_tr_b16 v[206:207], v7 offset:6656
  s_barrier
  v_add_u32 v2, 65536, v2
  v_add_u32 v3, 65536, v3
  v_add_u32 v4, 65536, v4
  v_add_u32 v5, 65536, v5
  ds_read_b128 v[24:27], v2 offset:16384
  v_mfma_f32_32x32x16_bf16 v[120:135], v[28:31], v[40:43], 0
  ds_read_b128 v[28:31], v3 offset:16384
  v_max3_f32 v15, v56, v57, v58
  v_max3_f32 v1, v59, v60, v61
  v_max3_f32 v15, v15, v62, v63
  v_max3_f32 v1, v1, v64, v65
  v_max3_f32 v15, v15, v66, v67
  s_waitcnt lgkmcnt(10)
  v_mfma_f32_32x32x16_bf16 v[136:151], v[32:35], v[40:43], 0
  ds_read_b128 v[32:35], v4 offset:16384
  v_max3_f32 v1, v1, v68, v69
  v_max3_f32 v15, v15, v70, v71
  v_max_f32 v15, v15, v1
  v_cmp_nge_f32 vcc, s67, v15
  v_mfma_f32_32x32x16_bf16 v[152:167], v[36:39], v[40:43], 0
  s_cbranch_vccnz L_A_stub1
L_A_back1:
  v_exp_f32 v56, v56
  ds_read_b128 v[36:39], v5 offset:16384
  v_exp_f32 v57, v57
  v_exp_f32 v58, v58
  v_add_f32 v9, v9, v56
  s_waitcnt lgkmcnt(8)
  v_mfma_f32_32x32x16_bf16 v[104:119], v[16:19], v[44:47], v[104:119]
  ds_read_b128 v[16:19], v2 offset:16896
  v_exp_f32 v59, v59
  v_add_f32 v10, v10, v57
  v_cvt_pk_bf16_f32 v56, v56, v57
  v_exp_f32 v60, v60
  v_mfma_f32_32x32x16_bf16 v[120:135], v[20:23], v[44:47], v[120:135]
  ds_read_b128 v[20:23], v3 offset:16896
  v_add_f32 v9, v9, v58
  v_exp_f32 v61, v61
  v_add_f32 v10, v10, v59
  s_waitcnt lgkmcnt(6)
  v_mfma_f32_32x32x16_bf16 v[136:151], v[200:203], v[44:47], v[136:151]
  ds_read_b128 v[200:203], v4 offset:16896
  v_cvt_pk_bf16_f32 v57, v58, v59
  v_exp_f32 v62, v62
  v_add_f32 v9, v9, v60
  v_mfma_f32_32x32x16_bf16 v[152:167], v[204:207], v[44:47], v[152:167]
  ds_read_b128 v[204:207], v5 offset:16896
  v_exp_f32 v63, v63
  v_add_f32 v10, v10, v61
  v_cvt_pk_bf16_f32 v58, v60, v61
  s_waitcnt lgkmcnt(6)
  v_mfma_f32_32x32x16_bf16 v[40:55], v[24:27], v[72:75], 0
  ds_read_b64_tr_b16 v[24:25], v6 offset:8192
  ds_read_b64_tr_b16 v[26:27], v6 offset:10240
  v_exp_f32 v64, v64
  v_add_f32 v9, v9, v62
  v_exp_f32 v65, v65
  v_mfma_f32_32x32x16_bf16 v[40:55], v[28:31], v[76:79], v[40:55]
  ds_read_b64_tr_b16 v[28:29], v7 offset:8192
  ds_read_b64_tr_b16 v[30:31], v7 offset:10240
  v_add_f32 v10, v10, v63
  v_cvt_pk_bf16_f32 v59, v62, v63
  v_exp_f32 v66, v66
  s_waitcnt lgkmcnt(8)
  v_mfma_f32_32x32x16_bf16 v[40:55], v[32:35], v[80:83], v[40:55]
  ds_read_b64_tr_b16 v[32:33], v6 offset:8704
  ds_read_b64_tr_b16 v[34:35], v6 offset:10752
  v_add_f32 v9, v9, v64
  v_exp_f32 v67, v67
  v_add_f32 v10, v10, v65
  v_mfma_f32_32x32x16_bf16 v[40:55], v[36:39], v[84:87], v[40:55]
  ds_read_b64_tr_b16 v[36:37], v7 offset:8704
  ds_read_b64_tr_b16 v[38:39], v7 offset:10752
  v_cvt_pk_bf16_f32 v60, v64, v65
  v_exp_f32 v68, v68
  v_add_f32 v9, v9, v66
  s_waitcnt lgkmcnt(10)
  v_mfma_f32_32x32x16_bf16 v[40:55], v[16:19], v[88:91], v[40:55]
  ds_read_b64_tr_b16 v[16:17], v6 offset:12288
  ds_read_b64_tr_b16 v[18:19], v6 offset:14336
  v_exp_f32 v69, v69
  v_add_f32 v10, v10, v67
  v_cvt_pk_bf16_f32 v61, v66, v67
  v_mfma_f32_32x32x16_bf16 v[40:55], v[20:23], v[92:95], v[40:55]
  ds_read_b64_tr_b16 v[20:21], v7 offset:12288
  ds_read_b64_tr_b16 v[22:23], v7 offset:14336
  v_exp_f32 v70, v70
  v_add_f32 v9, v9, v68
  v_exp_f32 v71, v71
  s_waitcnt lgkmcnt(12)
  v_mfma_f32_32x32x16_bf16 v[40:55], v[200:203], v[96:99], v[40:55]
  ds_read_b64_tr_b16 v[200:201], v6 offset:12800
  ds_read_b64_tr_b16 v[202:203], v6 offset:14848
  v_add_f32 v10, v10, v69
  v_cvt_pk_bf16_f32 v62, v68, v69
  v_add_f32 v9, v9, v70
  v_mfma_f32_32x32x16_bf16 v[40:55], v[204:207], v[100:103], v[40:55]
  v_add_f32 v10, v10, v71
  v_cvt_pk_bf16_f32 v63, v70, v71
  s_waitcnt lgkmcnt(10)
  v_mfma_f32_32x32x16_bf16 v[104:119], v[24:27], v[56:59], v[104:119]
  ds_read_b64_tr_b16 v[204:205], v7 offset:12800
  ds_read_b64_tr_b16 v[206:207], v7 offset:14848
  ds_read_b128 v[24:27], v2 offset:24576
  v_mfma_f32_32x32x16_bf16 v[120:135], v[28:31], v[56:59], v[120:135]
  ds_read_b128 v[28:31], v3 offset:24576
  s_nop 2
  v_max3_f32 v15, v40, v41, v42
  v_max3_f32 v1, v43, v44, v45
  v_max3_f32 v15, v15, v46, v47
  v_max3_f32 v1, v1, v48, v49
  v_max3_f32 v15, v15, v50, v51
  s_waitcnt lgkmcnt(10)
  v_mfma_f32_32x32x16_bf16 v[136:151], v[32:35], v[56:59], v[136:151]
  ds_read_b128 v[32:35], v4 offset:24576
  v_max3_f32 v1, v1, v52, v53
  v_max3_f32 v15, v15, v54, v55
  v_max_f32 v15, v15, v1
  v_cmp_nge_f32 vcc, s67, v15
  v_mfma_f32_32x32x16_bf16 v[152:167], v[36:39], v[56:59], v[152:167]
  s_cbranch_vccnz L_A_stub2
L_A_back2:
  v_exp_f32 v40, v40
  ds_read_b128 v[36:39], v5 offset:24576
  v_exp_f32 v41, v41
  v_exp_f32 v42, v42
  v_add_f32 v9, v9, v40
  s_waitcnt lgkmcnt(8)
  v_mfma_f32_32x32x16_bf16 v[104:119], v[16:19], v[60:63], v[104:119]
  ds_read_b128 v[16:19], v2 offset:25088
  v_exp_f32 v43, v43
  v_add_f32 v10, v10, v41
  v_cvt_pk_bf16_f32 v40, v40, v41
  v_exp_f32 v44, v44
  v_mfma_f32_32x32x16_bf16 v[120:135], v[20:23], v[60:63], v[120:135]
  ds_read_b128 v[20:23], v3 offset:25088
  v_add_f32 v9, v9, v42
  v_exp_f32 v45, v45
  v_add_f32 v10, v10, v43
  s_waitcnt lgkmcnt(6)
  v_mfma_f32_32x32x16_bf16 v[136:151], v[200:203], v[60:63], v[136:151]
  ds_read_b128 v[200:203], v4 offset:25088
  v_cvt_pk_bf16_f32 v41, v42, v43
  v_exp_f32 v46, v46
  v_add_f32 v9, v9, v44
  v_mfma_f32_32x32x16_bf16 v[152:167], v[204:207], v[60:63], v[152:167]
  ds_read_b128 v[204:207], v5 offset:25088
  v_exp_f32 v47, v47
  v_add_f32 v10, v10, v45
  v_cvt_pk_bf16_f32 v42, v44, v45
  s_waitcnt lgkmcnt(6)
  v_mfma_f32_32x32x16_bf16 v[56:71], v[24:27], v[72:75], 0
  s_barrier
  v_subrev_u32 v6, 131072, v6
  v_subrev_u32 v7, 131072, v7
  ds_read_b64_tr_b16 v[24:25], v6 offset:49152
  ds_read_b64_tr_b16 v[26:27], v6 offset:51200
  v_exp_f32 v48, v48
  v_add_f32 v9, v9, v46
  v_exp_f32 v49, v49
  v_mfma_f32_32x32x16_bf16 v[56:71], v[28:31], v[76:79], v[56:71]
  ds_read_b64_tr_b16 v[28:29], v7 offset:49152
  ds_read_b64_tr_b16 v[30:31], v7 offset:51200
  v_add_f32 v10, v10, v47
  v_cvt_pk_bf16_f32 v43, v46, v47
  v_exp_f32 v50, v50
  s_cmp_eq_u32 s58, 0
  s_cbranch_scc1 L_A_nopub
  s_waitcnt vmcnt(0)
  s_add_u32 s38, s45, 512
  v_mov_b32 v1, 1
  v_mov_b32 v15, 0
  s_mov_b64 s[52:53], exec
  s_mov_b64 exec, 1
  buffer_store_dword v1, v15, s[32:35], s38 offen sc1
  s_mov_b64 exec, s[52:53]
L_A_nopub:
  s_waitcnt lgkmcnt(8)
  v_mfma_f32_32x32x16_bf16 v[56:71], v[32:35], v[80:83], v[56:71]
  ds_read_b64_tr_b16 v[32:33], v6 offset:49664
  ds_read_b64_tr_b16 v[34:35], v6 offset:51712
  v_add_f32 v9, v9, v48
  v_exp_f32 v51, v51
  v_add_f32 v10, v10, v49
  v_mfma_f32_32x32x16_bf16 v[56:71], v[36:39], v[84:87], v[56:71]
  ds_read_b64_tr_b16 v[36:37], v7 offset:49664
  ds_read_b64_tr_b16 v[38:39], v7 offset:51712
  v_cvt_pk_bf16_f32 v44, v48, v49
  v_exp_f32 v52, v52
  v_add_f32 v9, v9, v50
  s_waitcnt lgkmcnt(10)
  v_mfma_f32_32x32x16_bf16 v[56:71], v[16:19], v[88:91], v[56:71]
  ds_read_b64_tr_b16 v[16:17], v6 offset:53248
  ds_read_b64_tr_b16 v[18:19], v6 offset:55296
  v_exp_f32 v53, v53
  v_add_f32 v10, v10, v51
  v_cvt_pk_bf16_f32 v45, v50, v51
  v_mfma_f32_32x32x16_bf16 v[56:71], v[20:23], v[92:95], v[56:71]
  ds_read_b64_tr_b16 v[20:21], v7 offset:53248
  ds_read_b64_tr_b16 v[22:23], v7 offset:55296
  v_exp_f32 v54, v54
  v_add_f32 v9, v9, v52
  v_exp_f32 v55, v55
  s_waitcnt lgkmcnt(12)
  v_mfma_f32_32x32x16_bf16 v[56:71], v[200:203], v[96:99], v[56:71]
  ds_read_b64_tr_b16 v[200:201], v6 offset:53760
  ds_read_b64_tr_b16 v[202:203], v6 offset:55808
  v_add_f32 v10, v10, v53
  v_cvt_pk_bf16_f32 v46, v52, v53
  v_add_f32 v9, v9, v54
  v_mfma_f32_32x32x16_bf16 v[56:71], v[204:207], v[100:103], v[56:71]
  v_add_f32 v10, v10, v55
  v_cvt_pk_bf16_f32 v47, v54, v55
  s_waitcnt lgkmcnt(10)
  v_mfma_f32_32x32x16_bf16 v[104:119], v[24:27], v[40:43], v[104:119]
  ds_read_b64_tr_b16 v[204:205], v7 offset:53760
  ds_read_b64_tr_b16 v[206:207], v7 offset:55808
  s_barrier
  v_subrev_u32 v2, 65536, v2
  v_subrev_u32 v3, 65536, v3
  v_subrev_u32 v4, 65536, v4
  v_subrev_u32 v5, 65536, v5
  ds_read_b128 v[24:27], v2 offset:0
  v_mfma_f32_32x32x16_bf16 v[120:135], v[28:31], v[40:43], v[120:135]
  ds_read_b128 v[28:31], v3 offset:0
  v_max3_f32 v15, v56, v57, v58
  v_max3_f32 v1, v59, v60, v61
  v_max3_f32 v15, v15, v62, v63
  v_max3_f32 v1, v1, v64, v65
  v_max3_f32 v15, v15, v66, v67
  s_waitcnt lgkmcnt(10)
  v_mfma_f32_32x32x16_bf16 v[136:151], v[32:35], v[40:43], v[136:151]
  ds_read_b128 v[32:35], v4 offset:0
  v_max3_f32 v1, v1, v68, v69
  v_max3_f32 v15, v15, v70, v71
  v_max_f32 v15, v15, v1
  v_cmp_nge_f32 vcc, s67, v15
  v_mfma_f32_32x32x16_bf16 v[152:167], v[36:39], v[40:43], v[152:167]
  s_cbranch_vccnz L_A_stub3
L_A_back3:
  v_exp_f32 v56, v56
  ds_read_b128 v[36:39], v5 offset:0
  v_exp_f32 v57, v57
  v_exp_f32 v58, v58
  v_add_f32 v9, v9, v56
  s_waitcnt lgkmcnt(8)
  v_mfma_f32_32x32x16_bf16 v[104:119], v[16:19], v[44:47], v[104:119]
  ds_read_b128 v[16:19], v2 offset:512
  v_exp_f32 v59, v59
  v_add_f32 v10, v10, v57
  v_cvt_pk_bf16_f32 v56, v56, v57
  v_exp_f32 v60, v60
  v_mfma_f32_32x32x16_bf16 v[120:135], v[20:23], v[44:47], v[120:135]
  ds_read_b128 v[20:23], v3 offset:512
  v_add_f32 v9, v9, v58
  v_exp_f32 v61, v61
  v_add_f32 v10, v10, v59
  s_waitcnt lgkmcnt(6)
  v_mfma_f32_32x32x16_bf16 v[136:151], v[200:203], v[44:47], v[136:151]
  ds_read_b128 v[200:203], v4 offset:512
  v_cvt_pk_bf16_f32 v57, v58, v59
  v_exp_f32 v62, v62
  v_add_f32 v9, v9, v60
  v_mfma_f32_32x32x16_bf16 v[152:167], v[204:207], v[44:47], v[152:167]
  ds_read_b128 v[204:207], v5 offset:512
  v_exp_f32 v63, v63
  v_add_f32 v10, v10, v61
  v_cvt_pk_bf16_f32 v58, v60, v61
  s_waitcnt lgkmcnt(6)
  v_mfma_f32_32x32x16_bf16 v[40:55], v[24:27], v[72:75], 0
  ds_read_b64_tr_b16 v[24:25], v6 offset:57344
  ds_read_b64_tr_b16 v[26:27], v6 offset:59392
  v_exp_f32 v64, v64
  v_add_f32 v9, v9, v62
  v_exp_f32 v65, v65
  v_mfma_f32_32x32x16_bf16 v[40:55], v[28:31], v[76:79], v[40:55]
  ds_read_b64_tr_b16 v[28:29], v7 offset:57344
  ds_read_b64_tr_b16 v[30:31], v7 offset:59392
  v_add_f32 v10, v10, v63
  v_cvt_pk_bf16_f32 v59, v62, v63
  v_exp_f32 v66, v66
  s_waitcnt lgkmcnt(8)
  v_mfma_f32_32x32x16_bf16 v[40:55], v[32:35], v[80:83], v[40:55]
  ds_read_b64_tr_b16 v[32:33], v6 offset:57856
  ds_read_b64_tr_b16 v[34:35], v6 offset:59904
  v_add_f32 v9, v9, v64
  v_exp_f32 v67, v67
  v_add_f32 v10, v10, v65
  v_mfma_f32_32x32x16_bf16 v[40:55], v[36:39], v[84:87], v[40:55]
  ds_read_b64_tr_b16 v[36:37], v7 offset:57856
  ds_read_b64_tr_b16 v[38:39], v7 offset:59904
  v_cvt_pk_bf16_f32 v60, v64, v65
  v_exp_f32 v68, v68
  v_add_f32 v9, v9, v66
  s_waitcnt lgkmcnt(10)
  v_mfma_f32_32x32x16_bf16 v[40:55], v[16:19], v[88:91], v[40:55]
  ds_read_b64_tr_b16 v[16:17], v6 offset:61440
  ds_read_b64_tr_b16 v[18:19], v6 offset:63488
  v_exp_f32 v69, v69
  v_add_f32 v10, v10, v67
  v_cvt_pk_bf16_f32 v61, v66, v67
  v_mfma_f32_32x32x16_bf16 v[40:55], v[20:23], v[92:95], v[40:55]
  ds_read_b64_tr_b16 v[20:21], v7 offset:61440
  ds_read_b64_tr_b16 v[22:23], v7 offset:63488
  v_exp_f32 v70, v70
  v_add_f32 v9, v9, v68
  v_exp_f32 v71, v71
  s_waitcnt lgkmcnt(12)
  v_mfma_f32_32x32x16_bf16 v[40:55], v[200:203], v[96:99], v[40:55]
  ds_read_b64_tr_b16 v[200:201], v6 offset:61952
  ds_read_b64_tr_b16 v[202:203], v6 offset:64000
  v_add_f32 v10, v10, v69
  v_cvt_pk_bf16_f32 v62, v68, v69
  v_add_f32 v9, v9, v70
  v_mfma_f32_32x32x16_bf16 v[40:55], v[204:207], v[100:103], v[40:55]
  v_add_f32 v10, v10, v71
  v_cvt_pk_bf16_f32 v63, v70, v71
  s_waitcnt lgkmcnt(10)
  v_mfma_f32_32x32x16_bf16 v[104:119], v[24:27], v[56:59], v[104:119]
  ds_read_b64_tr_b16 v[204:205], v7 offset:61952
  ds_read_b64_tr_b16 v[206:207], v7 offset:64000
  ds_read_b128 v[24:27], v2 offset:8192
  v_mfma_f32_32x32x16_bf16 v[120:135], v[28:31], v[56:59], v[120:135]
  ds_read_b128 v[28:31], v3 offset:8192
  s_nop 2
  v_max3_f32 v15, v40, v41, v42
  v_max3_f32 v1, v43, v44, v45
  v_max3_f32 v15, v15, v46, v47
  v_max3_f32 v1, v1, v48, v49
  v_max3_f32 v15, v15, v50, v51
  s_waitcnt lgkmcnt(10)
  v_mfma_f32_32x32x16_bf16 v[136:151], v[32:35], v[56:59], v[136:151]
  ds_read_b128 v[32:35], v4 offset:8192
  v_max3_f32 v1, v1, v52, v53
  v_max3_f32 v15, v15, v54, v55
  v_max_f32 v15, v15, v1
  v_cmp_nge_f32 vcc, s67, v15
  v_mfma_f32_32x32x16_bf16 v[152:167], v[36:39], v[56:59], v[152:167]
  s_cbranch_vccnz L_A_stub4
L_A_back4:
  v_exp_f32 v40, v40
  ds_read_b128 v[36:39], v5 offset:8192
  v_exp_f32 v41, v41
  v_exp_f32 v42, v42
  v_add_f32 v9, v9, v40
  s_waitcnt lgkmcnt(8)
  v_mfma_f32_32x32x16_bf16 v[104:119], v[16:19], v[60:63], v[104:119]
  ds_read_b128 v[16:19], v2 offset:8704
  v_exp_f32 v43, v43
  v_add_f32 v10, v10, v41
  v_cvt_pk_bf16_f32 v40, v40, v41
  v_exp_f32 v44, v44
  v_mfma_f32_32x32x16_bf16 v[120:135], v[20:23], v[60:63], v[120:135]
  ds_read_b128 v[20:23], v3 offset:8704
  v_add_f32 v9, v9, v42
  v_exp_f32 v45, v45
  v_add_f32 v10, v10, v43
  s_waitcnt lgkmcnt(6)
  v_mfma_f32_32x32x16_bf16 v[136:151], v[200:203], v[60:63], v[136:151]
  ds_read_b128 v[200:203], v4 offset:8704
  v_cvt_pk_bf16_f32 v41, v42, v43
  v_exp_f32 v46, v46
  v_add_f32 v9, v9, v44
  v_mfma_f32_32x32x16_bf16 v[152:167], v[204:207], v[60:63], v[152:167]
  ds_read_b128 v[204:207], v5 offset:8704
  v_exp_f32 v47, v47
  v_add_f32 v10, v10, v45
  v_cvt_pk_bf16_f32 v42, v44, v45
  s_waitcnt lgkmcnt(6)
  v_mfma_f32_32x32x16_bf16 v[56:71], v[24:27], v[72:75], 0
  s_barrier
  v_add_u32 v6, 65536, v6
  v_add_u32 v7, 65536, v7
  ds_read_b64_tr_b16 v[24:25], v6 offset:16384
  ds_read_b64_tr_b16 v[26:27], v6 offset:18432
  v_exp_f32 v48, v48
  v_add_f32 v9, v9, v46
  v_exp_f32 v49, v49
  v_mfma_f32_32x32x16_bf16 v[56:71], v[28:31], v[76:79], v[56:71]
  ds_read_b64_tr_b16 v[28:29], v7 offset:16384
  ds_read_b64_tr_b16 v[30:31], v7 offset:18432
  v_add_f32 v10, v10, v47
  v_cvt_pk_bf16_f32 v43, v46, v47
  v_exp_f32 v50, v50
  s_waitcnt lgkmcnt(8)
  v_mfma_f32_32x32x16_bf16 v[56:71], v[32:35], v[80:83], v[56:71]
  ds_read_b64_tr_b16 v[32:33], v6 offset:16896
  ds_read_b64_tr_b16 v[34:35], v6 offset:18944
  v_add_f32 v9, v9, v48
  v_exp_f32 v51, v51
  v_add_f32 v10, v10, v49
  v_mfma_f32_32x32x16_bf16 v[56:71], v[36:39], v[84:87], v[56:71]
  ds_read_b64_tr_b16 v[36:37], v7 offset:16896
  ds_read_b64_tr_b16 v[38:39], v7 offset:18944
  v_cvt_pk_bf16_f32 v44, v48, v49
  v_exp_f32 v52, v52
  v_add_f32 v9, v9, v50
  s_waitcnt lgkmcnt(10)
  v_mfma_f32_32x32x16_bf16 v[56:71], v[16:19], v[88:91], v[56:71]
  ds_read_b64_tr_b16 v[16:17], v6 offset:20480
  ds_read_b64_tr_b16 v[18:19], v6 offset:22528
  v_exp_f32 v53, v53
  v_add_f32 v10, v10, v51
  v_cvt_pk_bf16_f32 v45, v50, v51
  v_mfma_f32_32x32x16_bf16 v[56:71], v[20:23], v[92:95], v[56:71]
  ds_read_b64_tr_b16 v[20:21], v7 offset:20480
  ds_read_b64_tr_b16 v[22:23], v7 offset:22528
  v_exp_f32 v54, v54
  v_add_f32 v9, v9, v52
  v_exp_f32 v55, v55
  s_waitcnt lgkmcnt(12)
  v_mfma_f32_32x32x16_bf16 v[56:71], v[200:203], v[96:99], v[56:71]
  ds_read_b64_tr_b16 v[200:201], v6 offset:20992
  ds_read_b64_tr_b16 v[202:203], v6 offset:23040
  v_add_f32 v10, v10, v53
  v_cvt_pk_bf16_f32 v46, v52, v53
  v_add_f32 v9, v9, v54
  v_mfma_f32_32x32x16_bf16 v[56:71], v[204:207], v[100:103], v[56:71]
  v_add_f32 v10, v10, v55
  v_cvt_pk_bf16_f32 v47, v54, v55
  s_waitcnt lgkmcnt(10)
  v_mfma_f32_32x32x16_bf16 v[104:119], v[24:27], v[40:43], v[104:119]
  ds_read_b64_tr_b16 v[204:205], v7 offset:20992
  ds_read_b64_tr_b16 v[206:207], v7 offset:23040
  s_barrier
  ds_read_b128 v[24:27], v2 offset:32768
  v_mfma_f32_32x32x16_bf16 v[120:135], v[28:31], v[40:43], v[120:135]
  ds_read_b128 v[28:31], v3 offset:32768
  s_nop 1
  v_max3_f32 v15, v56, v57, v58
  v_max3_f32 v1, v59, v60, v61
  v_max3_f32 v15, v15, v62, v63
  v_max3_f32 v1, v1, v64, v65
  v_max3_f32 v15, v15, v66, v67
  s_waitcnt lgkmcnt(10)
  v_mfma_f32_32x32x16_bf16 v[136:151], v[32:35], v[40:43], v[136:151]
  ds_read_b128 v[32:35], v4 offset:32768
  v_max3_f32 v1, v1, v68, v69
  v_max3_f32 v15, v15, v70, v71
  v_max_f32 v15, v15, v1
  v_cmp_nge_f32 vcc, s67, v15
  v_mfma_f32_32x32x16_bf16 v[152:167], v[36:39], v[40:43], v[152:167]
  s_cbranch_vccnz L_A_stub5
L_A_back5:
  v_exp_f32 v56, v56
  ds_read_b128 v[36:39], v5 offset:32768
  v_exp_f32 v57, v57
  v_exp_f32 v58, v58
  v_add_f32 v9, v9, v56
  s_waitcnt lgkmcnt(8)
  v_mfma_f32_32x32x16_bf16 v[104:119], v[16:19], v[44:47], v[104:119]
  ds_read_b128 v[16:19], v2 offset:33280
  v_exp_f32 v59, v59
  v_add_f32 v10, v10, v57
  v_cvt_pk_bf16_f32 v56, v56, v57
  v_exp_f32 v60, v60
  v_mfma_f32_32x32x16_bf16 v[120:135], v[20:23], v[44:47], v[120:135]
  ds_read_b128 v[20:23], v3 offset:33280
  v_add_f32 v9, v9, v58
  v_exp_f32 v61, v61
  v_add_f32 v10, v10, v59
  s_waitcnt lgkmcnt(6)
  v_mfma_f32_32x32x16_bf16 v[136:151], v[200:203], v[44:47], v[136:151]
  ds_read_b128 v[200:203], v4 offset:33280
  v_cvt_pk_bf16_f32 v57, v58, v59
  v_exp_f32 v62, v62
  v_add_f32 v9, v9, v60
  v_mfma_f32_32x32x16_bf16 v[152:167], v[204:207], v[44:47], v[152:167]
  ds_read_b128 v[204:207], v5 offset:33280
  v_exp_f32 v63, v63
  v_add_f32 v10, v10, v61
  v_cvt_pk_bf16_f32 v58, v60, v61
  s_waitcnt lgkmcnt(6)
  v_mfma_f32_32x32x16_bf16 v[40:55], v[24:27], v[72:75], 0
  ds_read_b64_tr_b16 v[24:25], v6 offset:24576
  ds_read_b64_tr_b16 v[26:27], v6 offset:26624
  v_exp_f32 v64, v64
  v_add_f32 v9, v9, v62
  v_exp_f32 v65, v65
  v_mfma_f32_32x32x16_bf16 v[40:55], v[28:31], v[76:79], v[40:55]
  ds_read_b64_tr_b16 v[28:29], v7 offset:24576
  ds_read_b64_tr_b16 v[30:31], v7 offset:26624
  v_add_f32 v10, v10, v63
  v_cvt_pk_bf16_f32 v59, v62, v63
  v_exp_f32 v66, v66
  s_waitcnt lgkmcnt(8)
  v_mfma_f32_32x32x16_bf16 v[40:55], v[32:35], v[80:83], v[40:55]
  ds_read_b64_tr_b16 v[32:33], v6 offset:25088
  ds_read_b64_tr_b16 v[34:35], v6 offset:27136
  v_add_f32 v9, v9, v64
  v_exp_f32 v67, v67
  v_add_f32 v10, v10, v65
  v_mfma_f32_32x32x16_bf16 v[40:55], v[36:39], v[84:87], v[40:55]
  ds_read_b64_tr_b16 v[36:37], v7 offset:25088
  ds_read_b64_tr_b16 v[38:39], v7 offset:27136
  v_cvt_pk_bf16_f32 v60, v64, v65
  v_exp_f32 v68, v68
  v_add_f32 v9, v9, v66
  s_waitcnt lgkmcnt(10)
  v_mfma_f32_32x32x16_bf16 v[40:55], v[16:19], v[88:91], v[40:55]
  ds_read_b64_tr_b16 v[16:17], v6 offset:28672
  ds_read_b64_tr_b16 v[18:19], v6 offset:30720
  v_exp_f32 v69, v69
  v_add_f32 v10, v10, v67
  v_cvt_pk_bf16_f32 v61, v66, v67
  v_mfma_f32_32x32x16_bf16 v[40:55], v[20:23], v[92:95], v[40:55]
  ds_read_b64_tr_b16 v[20:21], v7 offset:28672
  ds_read_b64_tr_b16 v[22:23], v7 offset:30720
  v_exp_f32 v70, v70
  v_add_f32 v9, v9, v68
  v_exp_f32 v71, v71
  s_waitcnt lgkmcnt(12)
  v_mfma_f32_32x32x16_bf16 v[40:55], v[200:203], v[96:99], v[40:55]
  ds_read_b64_tr_b16 v[200:201], v6 offset:29184
  ds_read_b64_tr_b16 v[202:203], v6 offset:31232
  v_add_f32 v10, v10, v69
  v_cvt_pk_bf16_f32 v62, v68, v69
  v_add_f32 v9, v9, v70
  v_mfma_f32_32x32x16_bf16 v[40:55], v[204:207], v[100:103], v[40:55]
  v_add_f32 v10, v10, v71
  v_cvt_pk_bf16_f32 v63, v70, v71
  s_waitcnt lgkmcnt(10)
  v_mfma_f32_32x32x16_bf16 v[104:119], v[24:27], v[56:59], v[104:119]
  ds_read_b64_tr_b16 v[204:205], v7 offset:29184
  ds_read_b64_tr_b16 v[206:207], v7 offset:31232
  ds_read_b128 v[24:27], v2 offset:40960
  v_mfma_f32_32x32x16_bf16 v[120:135], v[28:31], v[56:59], v[120:135]
  ds_read_b128 v[28:31], v3 offset:40960
  s_nop 2
  v_max3_f32 v15, v40, v41, v42
  v_max3_f32 v1, v43, v44, v45
  v_max3_f32 v15, v15, v46, v47
  v_max3_f32 v1, v1, v48, v49
  v_max3_f32 v15, v15, v50, v51
  s_waitcnt lgkmcnt(10)
  v_mfma_f32_32x32x16_bf16 v[136:151], v[32:35], v[56:59], v[136:151]
  ds_read_b128 v[32:35], v4 offset:40960
  v_max3_f32 v1, v1, v52, v53
  v_max3_f32 v15, v15, v54, v55
  v_max_f32 v15, v15, v1
  v_cmp_nge_f32 vcc, s67, v15
  v_mfma_f32_32x32x16_bf16 v[152:167], v[36:39], v[56:59], v[152:167]
  s_cbranch_vccnz L_A_stub6
L_A_back6:
  v_exp_f32 v40, v40
  ds_read_b128 v[36:39], v5 offset:40960
  v_exp_f32 v41, v41
  v_exp_f32 v42, v42
  v_add_f32 v9, v9, v40
  s_waitcnt lgkmcnt(8)
  v_mfma_f32_32x32x16_bf16 v[104:119], v[16:19], v[60:63], v[104:119]
  ds_read_b128 v[16:19], v2 offset:41472
  v_exp_f32 v43, v43
  v_add_f32 v10, v10, v41
  v_cvt_pk_bf16_f32 v40, v40, v41
  v_exp_f32 v44, v44
  v_mfma_f32_32x32x16_bf16 v[120:135], v[20:23], v[60:63], v[120:135]
  ds_read_b128 v[20:23], v3 offset:41472
  v_add_f32 v9, v9, v42
  v_exp_f32 v45, v45
  v_add_f32 v10, v10, v43
  s_waitcnt lgkmcnt(6)
  v_mfma_f32_32x32x16_bf16 v[136:151], v[200:203], v[60:63], v[136:151]
  ds_read_b128 v[200:203], v4 offset:41472
  v_cvt_pk_bf16_f32 v41, v42, v43
  v_exp_f32 v46, v46
  v_add_f32 v9, v9, v44
  v_mfma_f32_32x32x16_bf16 v[152:167], v[204:207], v[60:63], v[152:167]
  ds_read_b128 v[204:207], v5 offset:41472
  v_exp_f32 v47, v47
  v_add_f32 v10, v10, v45
  v_cvt_pk_bf16_f32 v42, v44, v45
  s_waitcnt lgkmcnt(6)
  v_mfma_f32_32x32x16_bf16 v[56:71], v[24:27], v[72:75], 0
  s_barrier
  v_subrev_u32 v6, 65536, v6
  v_subrev_u32 v7, 65536, v7
  ds_read_b64_tr_b16 v[24:25], v6 offset:0
  ds_read_b64_tr_b16 v[26:27], v6 offset:2048
  v_exp_f32 v48, v48
  v_add_f32 v9, v9, v46
  v_exp_f32 v49, v49
  v_mfma_f32_32x32x16_bf16 v[56:71], v[28:31], v[76:79], v[56:71]
  ds_read_b64_tr_b16 v[28:29], v7 offset:0
  ds_read_b64_tr_b16 v[30:31], v7 offset:2048
  v_add_f32 v10, v10, v47
  v_cvt_pk_bf16_f32 v43, v46, v47
  v_exp_f32 v50, v50
  s_waitcnt lgkmcnt(8)
  v_mfma_f32_32x32x16_bf16 v[56:71], v[32:35], v[80:83], v[56:71]
  ds_read_b64_tr_b16 v[32:33], v6 offset:512
  ds_read_b64_tr_b16 v[34:35], v6 offset:2560
  v_add_f32 v9, v9, v48
  v_exp_f32 v51, v51
  v_add_f32 v10, v10, v49
  v_mfma_f32_32x32x16_bf16 v[56:71], v[36:39], v[84:87], v[56:71]
  ds_read_b64_tr_b16 v[36:37], v7 offset:512
  ds_read_b64_tr_b16 v[38:39], v7 offset:2560
  v_cvt_pk_bf16_f32 v44, v48, v49
  v_exp_f32 v52, v52
  v_add_f32 v9, v9, v50
  s_waitcnt lgkmcnt(10)
  v_mfma_f32_32x32x16_bf16 v[56:71], v[16:19], v[88:91], v[56:71]
  ds_read_b64_tr_b16 v[16:17], v6 offset:4096
  ds_read_b64_tr_b16 v[18:19], v6 offset:6144
  v_exp_f32 v53, v53
  v_add_f32 v10, v10, v51
  v_cvt_pk_bf16_f32 v45, v50, v51
  v_mfma_f32_32x32x16_bf16 v[56:71], v[20:23], v[92:95], v[56:71]
  ds_read_b64_tr_b16 v[20:21], v7 offset:4096
  ds_read_b64_tr_b16 v[22:23], v7 offset:6144
  v_exp_f32 v54, v54
  v_add_f32 v9, v9, v52
  v_exp_f32 v55, v55
  s_waitcnt lgkmcnt(12)
  v_mfma_f32_32x32x16_bf16 v[56:71], v[200:203], v[96:99], v[56:71]
  ds_read_b64_tr_b16 v[200:201], v6 offset:4608
  ds_read_b64_tr_b16 v[202:203], v6 offset:6656
  v_add_f32 v10, v10, v53
  v_cvt_pk_bf16_f32 v46, v52, v53
  v_add_f32 v9, v9, v54
  v_mfma_f32_32x32x16_bf16 v[56:71], v[204:207], v[100:103], v[56:71]
  v_add_f32 v10, v10, v55
  v_cvt_pk_bf16_f32 v47, v54, v55
  s_waitcnt lgkmcnt(10)
  v_mfma_f32_32x32x16_bf16 v[104:119], v[24:27], v[40:43], v[104:119]
  ds_read_b64_tr_b16 v[204:205], v7 offset:4608
  ds_read_b64_tr_b16 v[206:207], v7 offset:6656
  s_barrier
  ds_read_b128 v[24:27], v2 offset:49152
  v_mfma_f32_32x32x16_bf16 v[120:135], v[28:31], v[40:43], v[120:135]
  ds_read_b128 v[28:31], v3 offset:49152
  s_nop 1
  v_max3_f32 v15, v56, v57, v58
  v_max3_f32 v1, v59, v60, v61
  v_max3_f32 v15, v15, v62, v63
  v_max3_f32 v1, v1, v64, v65
  v_max3_f32 v15, v15, v66, v67
  s_waitcnt lgkmcnt(10)
  v_mfma_f32_32x32x16_bf16 v[136:151], v[32:35], v[40:43], v[136:151]
  ds_read_b128 v[32:35], v4 offset:49152
  v_max3_f32 v1, v1, v68, v69
  v_max3_f32 v15, v15, v70, v71
  v_max_f32 v15, v15, v1
  v_cmp_nge_f32 vcc, s67, v15
  v_mfma_f32_32x32x16_bf16 v[152:167], v[36:39], v[40:43], v[152:167]
  s_cbranch_vccnz L_A_stub7
L_A_back7:
  v_exp_f32 v56, v56
  ds_read_b128 v[36:39], v5 offset:49152
  v_exp_f32 v57, v57
  v_exp_f32 v58, v58
  v_add_f32 v9, v9, v56
  s_waitcnt lgkmcnt(8)
  v_mfma_f32_32x32x16_bf16 v[104:119], v[16:19], v[44:47], v[104:119]
  ds_read_b128 v[16:19], v2 offset:49664
  v_exp_f32 v59, v59
  v_add_f32 v10, v10, v57
  v_cvt_pk_bf16_f32 v56, v56, v57
  v_exp_f32 v60, v60
  v_mfma_f32_32x32x16_bf16 v[120:135], v[20:23], v[44:47], v[120:135]
  ds_read_b128 v[20:23], v3 offset:49664
  v_add_f32 v9, v9, v58
  v_exp_f32 v61, v61
  v_add_f32 v10, v10, v59
  s_waitcnt lgkmcnt(6)
  v_mfma_f32_32x32x16_bf16 v[136:151], v[200:203], v[44:47], v[136:151]
  ds_read_b128 v[200:203], v4 offset:49664
  v_cvt_pk_bf16_f32 v57, v58, v59
  v_exp_f32 v62, v62
  v_add_f32 v9, v9, v60
  v_mfma_f32_32x32x16_bf16 v[152:167], v[204:207], v[44:47], v[152:167]
  ds_read_b128 v[204:207], v5 offset:49664
  v_exp_f32 v63, v63
  v_add_f32 v10, v10, v61
  v_cvt_pk_bf16_f32 v58, v60, v61
  s_waitcnt lgkmcnt(6)
  v_mfma_f32_32x32x16_bf16 v[40:55], v[24:27], v[72:75], 0
  ds_read_b64_tr_b16 v[24:25], v6 offset:8192
  ds_read_b64_tr_b16 v[26:27], v6 offset:10240
  v_exp_f32 v64, v64
  v_add_f32 v9, v9, v62
  v_exp_f32 v65, v65
  v_mfma_f32_32x32x16_bf16 v[40:55], v[28:31], v[76:79], v[40:55]
  ds_read_b64_tr_b16 v[28:29], v7 offset:8192
  ds_read_b64_tr_b16 v[30:31], v7 offset:10240
  v_add_f32 v10, v10, v63
  v_cvt_pk_bf16_f32 v59, v62, v63
  v_exp_f32 v66, v66
  s_waitcnt lgkmcnt(8)
  v_mfma_f32_32x32x16_bf16 v[40:55], v[32:35], v[80:83], v[40:55]
  ds_read_b64_tr_b16 v[32:33], v6 offset:8704
  ds_read_b64_tr_b16 v[34:35], v6 offset:10752
  v_add_f32 v9, v9, v64
  v_exp_f32 v67, v67
  v_add_f32 v10, v10, v65
  v_mfma_f32_32x32x16_bf16 v[40:55], v[36:39], v[84:87], v[40:55]
  ds_read_b64_tr_b16 v[36:37], v7 offset:8704
  ds_read_b64_tr_b16 v[38:39], v7 offset:10752
  v_cvt_pk_bf16_f32 v60, v64, v65
  v_exp_f32 v68, v68
  v_add_f32 v9, v9, v66
  s_waitcnt lgkmcnt(10)
  v_mfma_f32_32x32x16_bf16 v[40:55], v[16:19], v[88:91], v[40:55]
  ds_read_b64_tr_b16 v[16:17], v6 offset:12288
  ds_read_b64_tr_b16 v[18:19], v6 offset:14336
  v_exp_f32 v69, v69
  v_add_f32 v10, v10, v67
  v_cvt_pk_bf16_f32 v61, v66, v67
  v_mfma_f32_32x32x16_bf16 v[40:55], v[20:23], v[92:95], v[40:55]
  ds_read_b64_tr_b16 v[20:21], v7 offset:12288
  ds_read_b64_tr_b16 v[22:23], v7 offset:14336
  v_exp_f32 v70, v70
  v_add_f32 v9, v9, v68
  v_exp_f32 v71, v71
  s_waitcnt lgkmcnt(12)
  v_mfma_f32_32x32x16_bf16 v[40:55], v[200:203], v[96:99], v[40:55]
  ds_read_b64_tr_b16 v[200:201], v6 offset:12800
  ds_read_b64_tr_b16 v[202:203], v6 offset:14848
  v_add_f32 v10, v10, v69
  v_cvt_pk_bf16_f32 v62, v68, v69
  v_add_f32 v9, v9, v70
  v_mfma_f32_32x32x16_bf16 v[40:55], v[204:207], v[100:103], v[40:55]
  v_add_f32 v10, v10, v71
  v_cvt_pk_bf16_f32 v63, v70, v71
  s_waitcnt lgkmcnt(10)
  v_mfma_f32_32x32x16_bf16 v[104:119], v[24:27], v[56:59], v[104:119]
  ds_read_b64_tr_b16 v[204:205], v7 offset:12800
  ds_read_b64_tr_b16 v[206:207], v7 offset:14848
  ds_read_b128 v[24:27], v2 offset:57344
  v_mfma_f32_32x32x16_bf16 v[120:135], v[28:31], v[56:59], v[120:135]
  ds_read_b128 v[28:31], v3 offset:57344
  s_nop 2
  v_max3_f32 v15, v40, v41, v42
  v_max3_f32 v1, v43, v44, v45
  v_max3_f32 v15, v15, v46, v47
  v_max3_f32 v1, v1, v48, v49
  v_max3_f32 v15, v15, v50, v51
  s_waitcnt lgkmcnt(10)
  v_mfma_f32_32x32x16_bf16 v[136:151], v[32:35], v[56:59], v[136:151]
  ds_read_b128 v[32:35], v4 offset:57344
  v_max3_f32 v1, v1, v52, v53
  v_max3_f32 v15, v15, v54, v55
  v_max_f32 v15, v15, v1
  v_cmp_nge_f32 vcc, s67, v15
  v_mfma_f32_32x32x16_bf16 v[152:167], v[36:39], v[56:59], v[152:167]
  s_cbranch_vccnz L_A_stub8
L_A_back8:
  v_exp_f32 v40, v40
  ds_read_b128 v[36:39], v5 offset:57344
  v_exp_f32 v41, v41
  v_exp_f32 v42, v42
  v_add_f32 v9, v9, v40
  s_waitcnt lgkmcnt(8)
  v_mfma_f32_32x32x16_bf16 v[104:119], v[16:19], v[60:63], v[104:119]
  ds_read_b128 v[16:19], v2 offset:57856
  v_exp_f32 v43, v43
  v_add_f32 v10, v10, v41
  v_cvt_pk_bf16_f32 v40, v40, v41
  v_exp_f32 v44, v44
  v_mfma_f32_32x32x16_bf16 v[120:135], v[20:23], v[60:63], v[120:135]
  ds_read_b128 v[20:23], v3 offset:57856
  v_add_f32 v9, v9, v42
  v_exp_f32 v45, v45
  v_add_f32 v10, v10, v43
  s_waitcnt lgkmcnt(6)
  v_mfma_f32_32x32x16_bf16 v[136:151], v[200:203], v[60:63], v[136:151]
  ds_read_b128 v[200:203], v4 offset:57856
  v_cvt_pk_bf16_f32 v41, v42, v43
  v_exp_f32 v46, v46
  v_add_f32 v9, v9, v44
  v_mfma_f32_32x32x16_bf16 v[152:167], v[204:207], v[60:63], v[152:167]
  ds_read_b128 v[204:207], v5 offset:57856
  v_exp_f32 v47, v47
  v_add_f32 v10, v10, v45
  v_cvt_pk_bf16_f32 v42, v44, v45
  s_waitcnt lgkmcnt(6)
  v_mfma_f32_32x32x16_bf16 v[56:71], v[24:27], v[72:75], 0
  s_barrier
  v_add_u32 v6, 131072, v6
  v_add_u32 v7, 131072, v7
  ds_read_b64_tr_b16 v[24:25], v6 offset:0
  ds_read_b64_tr_b16 v[26:27], v6 offset:2048
  v_exp_f32 v48, v48
  v_add_f32 v9, v9, v46
  v_exp_f32 v49, v49
  v_mfma_f32_32x32x16_bf16 v[56:71], v[28:31], v[76:79], v[56:71]
  ds_read_b64_tr_b16 v[28:29], v7 offset:0
  ds_read_b64_tr_b16 v[30:31], v7 offset:2048
  v_add_f32 v10, v10, v47
  v_cvt_pk_bf16_f32 v43, v46, v47
  v_exp_f32 v50, v50
  s_waitcnt lgkmcnt(8)
  v_mfma_f32_32x32x16_bf16 v[56:71], v[32:35], v[80:83], v[56:71]
  ds_read_b64_tr_b16 v[32:33], v6 offset:512
  ds_read_b64_tr_b16 v[34:35], v6 offset:2560
  v_add_f32 v9, v9, v48
  v_exp_f32 v51, v51
  v_add_f32 v10, v10, v49
  v_mfma_f32_32x32x16_bf16 v[56:71], v[36:39], v[84:87], v[56:71]
  ds_read_b64_tr_b16 v[36:37], v7 offset:512
  ds_read_b64_tr_b16 v[38:39], v7 offset:2560
  v_cvt_pk_bf16_f32 v44, v48, v49
  v_exp_f32 v52, v52
  v_add_f32 v9, v9, v50
  s_waitcnt lgkmcnt(10)
  v_mfma_f32_32x32x16_bf16 v[56:71], v[16:19], v[88:91], v[56:71]
  ds_read_b64_tr_b16 v[16:17], v6 offset:4096
  ds_read_b64_tr_b16 v[18:19], v6 offset:6144
  v_exp_f32 v53, v53
  v_add_f32 v10, v10, v51
  v_cvt_pk_bf16_f32 v45, v50, v51
  v_mfma_f32_32x32x16_bf16 v[56:71], v[20:23], v[92:95], v[56:71]
  ds_read_b64_tr_b16 v[20:21], v7 offset:4096
  ds_read_b64_tr_b16 v[22:23], v7 offset:6144
  v_exp_f32 v54, v54
  v_add_f32 v9, v9, v52
  v_exp_f32 v55, v55
  s_waitcnt lgkmcnt(12)
  v_mfma_f32_32x32x16_bf16 v[56:71], v[200:203], v[96:99], v[56:71]
  ds_read_b64_tr_b16 v[200:201], v6 offset:4608
  ds_read_b64_tr_b16 v[202:203], v6 offset:6656
  v_add_f32 v10, v10, v53
  v_cvt_pk_bf16_f32 v46, v52, v53
  v_add_f32 v9, v9, v54
  v_mfma_f32_32x32x16_bf16 v[56:71], v[204:207], v[100:103], v[56:71]
  v_add_f32 v10, v10, v55
  v_cvt_pk_bf16_f32 v47, v54, v55
  s_waitcnt lgkmcnt(10)
  v_mfma_f32_32x32x16_bf16 v[104:119], v[24:27], v[40:43], v[104:119]
  ds_read_b64_tr_b16 v[204:205], v7 offset:4608
  ds_read_b64_tr_b16 v[206:207], v7 offset:6656
  s_barrier
  v_add_u32 v2, 65536, v2
  v_add_u32 v3, 65536, v3
  v_add_u32 v4, 65536, v4
  v_add_u32 v5, 65536, v5
  ds_read_b128 v[24:27], v2 offset:16384
  v_mfma_f32_32x32x16_bf16 v[120:135], v[28:31], v[40:43], v[120:135]
  ds_read_b128 v[28:31], v3 offset:16384
  v_max3_f32 v15, v56, v57, v58
  v_max3_f32 v1, v59, v60, v61
  v_max3_f32 v15, v15, v62, v63
  v_max3_f32 v1, v1, v64, v65
  v_max3_f32 v15, v15, v66, v67
  s_waitcnt lgkmcnt(10)
  v_mfma_f32_32x32x16_bf16 v[136:151], v[32:35], v[40:43], v[136:151]
  ds_read_b128 v[32:35], v4 offset:16384
  v_max3_f32 v1, v1, v68, v69
  v_max3_f32 v15, v15, v70, v71
  v_max_f32 v15, v15, v1
  v_cmp_nge_f32 vcc, s67, v15
  v_mfma_f32_32x32x16_bf16 v[152:167], v[36:39], v[40:43], v[152:167]
  s_cbranch_vccnz L_A_stub9
L_A_back9:
  v_exp_f32 v56, v56
  ds_read_b128 v[36:39], v5 offset:16384
  v_exp_f32 v57, v57
  v_exp_f32 v58, v58
  v_add_f32 v9, v9, v56
  s_waitcnt lgkmcnt(8)
  v_mfma_f32_32x32x16_bf16 v[104:119], v[16:19], v[44:47], v[104:119]
  ds_read_b128 v[16:19], v2 offset:16896
  v_exp_f32 v59, v59
  v_add_f32 v10, v10, v57
  v_cvt_pk_bf16_f32 v56, v56, v57
  v_exp_f32 v60, v60
  v_mfma_f32_32x32x16_bf16 v[120:135], v[20:23], v[44:47], v[120:135]
  ds_read_b128 v[20:23], v3 offset:16896
  v_add_f32 v9, v9, v58
  v_exp_f32 v61, v61
  v_add_f32 v10, v10, v59
  s_waitcnt lgkmcnt(6)
  v_mfma_f32_32x32x16_bf16 v[136:151], v[200:203], v[44:47], v[136:151]
  ds_read_b128 v[200:203], v4 offset:16896
  v_cvt_pk_bf16_f32 v57, v58, v59
  v_exp_f32 v62, v62
  v_add_f32 v9, v9, v60
  v_mfma_f32_32x32x16_bf16 v[152:167], v[204:207], v[44:47], v[152:167]
  ds_read_b128 v[204:207], v5 offset:16896
  v_exp_f32 v63, v63
  v_add_f32 v10, v10, v61
  v_cvt_pk_bf16_f32 v58, v60, v61
  s_waitcnt lgkmcnt(6)
  v_mfma_f32_32x32x16_bf16 v[40:55], v[24:27], v[72:75], 0
  ds_read_b64_tr_b16 v[24:25], v6 offset:8192
  ds_read_b64_tr_b16 v[26:27], v6 offset:10240
  v_exp_f32 v64, v64
  v_add_f32 v9, v9, v62
  v_exp_f32 v65, v65
  v_mfma_f32_32x32x16_bf16 v[40:55], v[28:31], v[76:79], v[40:55]
  ds_read_b64_tr_b16 v[28:29], v7 offset:8192
  ds_read_b64_tr_b16 v[30:31], v7 offset:10240
  v_add_f32 v10, v10, v63
  v_cvt_pk_bf16_f32 v59, v62, v63
  v_exp_f32 v66, v66
  s_waitcnt lgkmcnt(8)
  v_mfma_f32_32x32x16_bf16 v[40:55], v[32:35], v[80:83], v[40:55]
  ds_read_b64_tr_b16 v[32:33], v6 offset:8704
  ds_read_b64_tr_b16 v[34:35], v6 offset:10752
  v_add_f32 v9, v9, v64
  v_exp_f32 v67, v67
  v_add_f32 v10, v10, v65
  v_mfma_f32_32x32x16_bf16 v[40:55], v[36:39], v[84:87], v[40:55]
  ds_read_b64_tr_b16 v[36:37], v7 offset:8704
  ds_read_b64_tr_b16 v[38:39], v7 offset:10752
  v_cvt_pk_bf16_f32 v60, v64, v65
  v_exp_f32 v68, v68
  v_add_f32 v9, v9, v66
  s_waitcnt lgkmcnt(10)
  v_mfma_f32_32x32x16_bf16 v[40:55], v[16:19], v[88:91], v[40:55]
  ds_read_b64_tr_b16 v[16:17], v6 offset:12288
  ds_read_b64_tr_b16 v[18:19], v6 offset:14336
  v_exp_f32 v69, v69
  v_add_f32 v10, v10, v67
  v_cvt_pk_bf16_f32 v61, v66, v67
  v_mfma_f32_32x32x16_bf16 v[40:55], v[20:23], v[92:95], v[40:55]
  ds_read_b64_tr_b16 v[20:21], v7 offset:12288
  ds_read_b64_tr_b16 v[22:23], v7 offset:14336
  v_exp_f32 v70, v70
  v_add_f32 v9, v9, v68
  v_exp_f32 v71, v71
  s_waitcnt lgkmcnt(12)
  v_mfma_f32_32x32x16_bf16 v[40:55], v[200:203], v[96:99], v[40:55]
  ds_read_b64_tr_b16 v[200:201], v6 offset:12800
  ds_read_b64_tr_b16 v[202:203], v6 offset:14848
  v_add_f32 v10, v10, v69
  v_cvt_pk_bf16_f32 v62, v68, v69
  v_add_f32 v9, v9, v70
  v_mfma_f32_32x32x16_bf16 v[40:55], v[204:207], v[100:103], v[40:55]
  v_add_f32 v10, v10, v71
  v_cvt_pk_bf16_f32 v63, v70, v71
  s_waitcnt lgkmcnt(10)
  v_mfma_f32_32x32x16_bf16 v[104:119], v[24:27], v[56:59], v[104:119]
  ds_read_b64_tr_b16 v[204:205], v7 offset:12800
  ds_read_b64_tr_b16 v[206:207], v7 offset:14848
  ds_read_b128 v[24:27], v2 offset:24576
  v_mfma_f32_32x32x16_bf16 v[120:135], v[28:31], v[56:59], v[120:135]
  ds_read_b128 v[28:31], v3 offset:24576
  s_nop 2
  v_max3_f32 v15, v40, v41, v42
  v_max3_f32 v1, v43, v44, v45
  v_max3_f32 v15, v15, v46, v47
  v_max3_f32 v1, v1, v48, v49
  v_max3_f32 v15, v15, v50, v51
  s_waitcnt lgkmcnt(10)
  v_mfma_f32_32x32x16_bf16 v[136:151], v[32:35], v[56:59], v[136:151]
  ds_read_b128 v[32:35], v4 offset:24576
  v_max3_f32 v1, v1, v52, v53
  v_max3_f32 v15, v15, v54, v55
  v_max_f32 v15, v15, v1
  v_cmp_nge_f32 vcc, s67, v15
  v_mfma_f32_32x32x16_bf16 v[152:167], v[36:39], v[56:59], v[152:167]
  s_cbranch_vccnz L_A_stub10
L_A_back10:
  v_exp_f32 v40, v40
  ds_read_b128 v[36:39], v5 offset:24576
  v_exp_f32 v41, v41
  v_exp_f32 v42, v42
  v_add_f32 v9, v9, v40
  s_waitcnt lgkmcnt(8)
  v_mfma_f32_32x32x16_bf16 v[104:119], v[16:19], v[60:63], v[104:119]
  ds_read_b128 v[16:19], v2 offset:25088
  v_exp_f32 v43, v43
  v_add_f32 v10, v10, v41
  v_cvt_pk_bf16_f32 v40, v40, v41
  v_exp_f32 v44, v44
  v_mfma_f32_32x32x16_bf16 v[120:135], v[20:23], v[60:63], v[120:135]
  ds_read_b128 v[20:23], v3 offset:25088
  v_add_f32 v9, v9, v42
  v_exp_f32 v45, v45
  v_add_f32 v10, v10, v43
  s_waitcnt lgkmcnt(6)
  v_mfma_f32_32x32x16_bf16 v[136:151], v[200:203], v[60:63], v[136:151]
  ds_read_b128 v[200:203], v4 offset:25088
  v_cvt_pk_bf16_f32 v41, v42, v43
  v_exp_f32 v46, v46
  v_add_f32 v9, v9, v44
  v_mfma_f32_32x32x16_bf16 v[152:167], v[204:207], v[60:63], v[152:167]
  ds_read_b128 v[204:207], v5 offset:25088
  v_exp_f32 v47, v47
  v_add_f32 v10, v10, v45
  v_cvt_pk_bf16_f32 v42, v44, v45
  s_waitcnt lgkmcnt(6)
  v_mfma_f32_32x32x16_bf16 v[56:71], v[24:27], v[72:75], 0
  s_barrier
  v_subrev_u32 v6, 131072, v6
  v_subrev_u32 v7, 131072, v7
  ds_read_b64_tr_b16 v[24:25], v6 offset:49152
  ds_read_b64_tr_b16 v[26:27], v6 offset:51200
  v_exp_f32 v48, v48
  v_add_f32 v9, v9, v46
  v_exp_f32 v49, v49
  v_mfma_f32_32x32x16_bf16 v[56:71], v[28:31], v[76:79], v[56:71]
  ds_read_b64_tr_b16 v[28:29], v7 offset:49152
  ds_read_b64_tr_b16 v[30:31], v7 offset:51200
  v_add_f32 v10, v10, v47
  v_cvt_pk_bf16_f32 v43, v46, v47
  v_exp_f32 v50, v50
  s_waitcnt lgkmcnt(8)
  v_mfma_f32_32x32x16_bf16 v[56:71], v[32:35], v[80:83], v[56:71]
  ds_read_b64_tr_b16 v[32:33], v6 offset:49664
  ds_read_b64_tr_b16 v[34:35], v6 offset:51712
  v_add_f32 v9, v9, v48
  v_exp_f32 v51, v51
  v_add_f32 v10, v10, v49
  v_mfma_f32_32x32x16_bf16 v[56:71], v[36:39], v[84:87], v[56:71]
  ds_read_b64_tr_b16 v[36:37], v7 offset:49664
  ds_read_b64_tr_b16 v[38:39], v7 offset:51712
  v_cvt_pk_bf16_f32 v44, v48, v49
  v_exp_f32 v52, v52
  v_add_f32 v9, v9, v50
  s_waitcnt lgkmcnt(10)
  v_mfma_f32_32x32x16_bf16 v[56:71], v[16:19], v[88:91], v[56:71]
  ds_read_b64_tr_b16 v[16:17], v6 offset:53248
  ds_read_b64_tr_b16 v[18:19], v6 offset:55296
  v_exp_f32 v53, v53
  v_add_f32 v10, v10, v51
  v_cvt_pk_bf16_f32 v45, v50, v51
  v_mfma_f32_32x32x16_bf16 v[56:71], v[20:23], v[92:95], v[56:71]
  ds_read_b64_tr_b16 v[20:21], v7 offset:53248
  ds_read_b64_tr_b16 v[22:23], v7 offset:55296
  v_exp_f32 v54, v54
  v_add_f32 v9, v9, v52
  v_exp_f32 v55, v55
  s_waitcnt lgkmcnt(12)
  v_mfma_f32_32x32x16_bf16 v[56:71], v[200:203], v[96:99], v[56:71]
  ds_read_b64_tr_b16 v[200:201], v6 offset:53760
  ds_read_b64_tr_b16 v[202:203], v6 offset:55808
  v_add_f32 v10, v10, v53
  v_cvt_pk_bf16_f32 v46, v52, v53
  v_add_f32 v9, v9, v54
  v_mfma_f32_32x32x16_bf16 v[56:71], v[204:207], v[100:103], v[56:71]
  v_add_f32 v10, v10, v55
  v_cvt_pk_bf16_f32 v47, v54, v55
  s_waitcnt lgkmcnt(10)
  v_mfma_f32_32x32x16_bf16 v[104:119], v[24:27], v[40:43], v[104:119]
  ds_read_b64_tr_b16 v[204:205], v7 offset:53760
  ds_read_b64_tr_b16 v[206:207], v7 offset:55808
  s_barrier
  v_subrev_u32 v2, 65536, v2
  v_subrev_u32 v3, 65536, v3
  v_subrev_u32 v4, 65536, v4
  v_subrev_u32 v5, 65536, v5
  ds_read_b128 v[24:27], v2 offset:0
  v_mfma_f32_32x32x16_bf16 v[120:135], v[28:31], v[40:43], v[120:135]
  ds_read_b128 v[28:31], v3 offset:0
  v_max3_f32 v15, v56, v57, v58
  v_max3_f32 v1, v59, v60, v61
  v_max3_f32 v15, v15, v62, v63
  v_max3_f32 v1, v1, v64, v65
  v_max3_f32 v15, v15, v66, v67
  s_waitcnt lgkmcnt(10)
  v_mfma_f32_32x32x16_bf16 v[136:151], v[32:35], v[40:43], v[136:151]
  ds_read_b128 v[32:35], v4 offset:0
  v_max3_f32 v1, v1, v68, v69
  v_max3_f32 v15, v15, v70, v71
  v_max_f32 v15, v15, v1
  v_cmp_nge_f32 vcc, s67, v15
  v_mfma_f32_32x32x16_bf16 v[152:167], v[36:39], v[40:43], v[152:167]
  s_cbranch_vccnz L_A_stub11
L_A_back11:
  v_exp_f32 v56, v56
  ds_read_b128 v[36:39], v5 offset:0
  v_exp_f32 v57, v57
  v_exp_f32 v58, v58
  v_add_f32 v9, v9, v56
  s_waitcnt lgkmcnt(8)
  v_mfma_f32_32x32x16_bf16 v[104:119], v[16:19], v[44:47], v[104:119]
  ds_read_b128 v[16:19], v2 offset:512
  v_exp_f32 v59, v59
  v_add_f32 v10, v10, v57
  v_cvt_pk_bf16_f32 v56, v56, v57
  v_exp_f32 v60, v60
  v_mfma_f32_32x32x16_bf16 v[120:135], v[20:23], v[44:47], v[120:135]
  ds_read_b128 v[20:23], v3 offset:512
  v_add_f32 v9, v9, v58
  v_exp_f32 v61, v61
  v_add_f32 v10, v10, v59
  s_waitcnt lgkmcnt(6)
  v_mfma_f32_32x32x16_bf16 v[136:151], v[200:203], v[44:47], v[136:151]
  ds_read_b128 v[200:203], v4 offset:512
  v_cvt_pk_bf16_f32 v57, v58, v59
  v_exp_f32 v62, v62
  v_add_f32 v9, v9, v60
  v_mfma_f32_32x32x16_bf16 v[152:167], v[204:207], v[44:47], v[152:167]
  ds_read_b128 v[204:207], v5 offset:512
  v_exp_f32 v63, v63
  v_add_f32 v10, v10, v61
  v_cvt_pk_bf16_f32 v58, v60, v61
  s_waitcnt lgkmcnt(6)
  v_mfma_f32_32x32x16_bf16 v[40:55], v[24:27], v[72:75], 0
  ds_read_b64_tr_b16 v[24:25], v6 offset:57344
  ds_read_b64_tr_b16 v[26:27], v6 offset:59392
  v_exp_f32 v64, v64
  v_add_f32 v9, v9, v62
  v_exp_f32 v65, v65
  v_mfma_f32_32x32x16_bf16 v[40:55], v[28:31], v[76:79], v[40:55]
  ds_read_b64_tr_b16 v[28:29], v7 offset:57344
  ds_read_b64_tr_b16 v[30:31], v7 offset:59392
  v_add_f32 v10, v10, v63
  v_cvt_pk_bf16_f32 v59, v62, v63
  v_exp_f32 v66, v66
  s_waitcnt lgkmcnt(8)
  v_mfma_f32_32x32x16_bf16 v[40:55], v[32:35], v[80:83], v[40:55]
  ds_read_b64_tr_b16 v[32:33], v6 offset:57856
  ds_read_b64_tr_b16 v[34:35], v6 offset:59904
  v_add_f32 v9, v9, v64
  v_exp_f32 v67, v67
  v_add_f32 v10, v10, v65
  v_mfma_f32_32x32x16_bf16 v[40:55], v[36:39], v[84:87], v[40:55]
  ds_read_b64_tr_b16 v[36:37], v7 offset:57856
  ds_read_b64_tr_b16 v[38:39], v7 offset:59904
  v_cvt_pk_bf16_f32 v60, v64, v65
  v_exp_f32 v68, v68
  v_add_f32 v9, v9, v66
  s_waitcnt lgkmcnt(10)
  v_mfma_f32_32x32x16_bf16 v[40:55], v[16:19], v[88:91], v[40:55]
  ds_read_b64_tr_b16 v[16:17], v6 offset:61440
  ds_read_b64_tr_b16 v[18:19], v6 offset:63488
  v_exp_f32 v69, v69
  v_add_f32 v10, v10, v67
  v_cvt_pk_bf16_f32 v61, v66, v67
  v_mfma_f32_32x32x16_bf16 v[40:55], v[20:23], v[92:95], v[40:55]
  ds_read_b64_tr_b16 v[20:21], v7 offset:61440
  ds_read_b64_tr_b16 v[22:23], v7 offset:63488
  v_exp_f32 v70, v70
  v_add_f32 v9, v9, v68
  v_exp_f32 v71, v71
  s_waitcnt lgkmcnt(12)
  v_mfma_f32_32x32x16_bf16 v[40:55], v[200:203], v[96:99], v[40:55]
  ds_read_b64_tr_b16 v[200:201], v6 offset:61952
  ds_read_b64_tr_b16 v[202:203], v6 offset:64000
  v_add_f32 v10, v10, v69
  v_cvt_pk_bf16_f32 v62, v68, v69
  v_add_f32 v9, v9, v70
  v_mfma_f32_32x32x16_bf16 v[40:55], v[204:207], v[100:103], v[40:55]
  v_add_f32 v10, v10, v71
  v_cvt_pk_bf16_f32 v63, v70, v71
  s_waitcnt lgkmcnt(10)
  v_mfma_f32_32x32x16_bf16 v[104:119], v[24:27], v[56:59], v[104:119]
  ds_read_b64_tr_b16 v[204:205], v7 offset:61952
  ds_read_b64_tr_b16 v[206:207], v7 offset:64000
  ds_read_b128 v[24:27], v2 offset:8192
  v_mfma_f32_32x32x16_bf16 v[120:135], v[28:31], v[56:59], v[120:135]
  ds_read_b128 v[28:31], v3 offset:8192
  s_nop 2
  v_max3_f32 v15, v40, v41, v42
  v_max3_f32 v1, v43, v44, v45
  v_max3_f32 v15, v15, v46, v47
  v_max3_f32 v1, v1, v48, v49
  v_max3_f32 v15, v15, v50, v51
  s_waitcnt lgkmcnt(10)
  v_mfma_f32_32x32x16_bf16 v[136:151], v[32:35], v[56:59], v[136:151]
  ds_read_b128 v[32:35], v4 offset:8192
  v_max3_f32 v1, v1, v52, v53
  v_max3_f32 v15, v15, v54, v55
  v_max_f32 v15, v15, v1
  v_cmp_nge_f32 vcc, s67, v15
  v_mfma_f32_32x32x16_bf16 v[152:167], v[36:39], v[56:59], v[152:167]
  s_cbranch_vccnz L_A_stub12
L_A_back12:
  v_exp_f32 v40, v40
  ds_read_b128 v[36:39], v5 offset:8192
  v_exp_f32 v41, v41
  v_exp_f32 v42, v42
  v_add_f32 v9, v9, v40
  s_waitcnt lgkmcnt(8)
  v_mfma_f32_32x32x16_bf16 v[104:119], v[16:19], v[60:63], v[104:119]
  ds_read_b128 v[16:19], v2 offset:8704
  v_exp_f32 v43, v43
  v_add_f32 v10, v10, v41
  v_cvt_pk_bf16_f32 v40, v40, v41
  v_exp_f32 v44, v44
  v_mfma_f32_32x32x16_bf16 v[120:135], v[20:23], v[60:63], v[120:135]
  ds_read_b128 v[20:23], v3 offset:8704
  v_add_f32 v9, v9, v42
  v_exp_f32 v45, v45
  v_add_f32 v10, v10, v43
  s_waitcnt lgkmcnt(6)
  v_mfma_f32_32x32x16_bf16 v[136:151], v[200:203], v[60:63], v[136:151]
  ds_read_b128 v[200:203], v4 offset:8704
  v_cvt_pk_bf16_f32 v41, v42, v43
  v_exp_f32 v46, v46
  v_add_f32 v9, v9, v44
  v_mfma_f32_32x32x16_bf16 v[152:167], v[204:207], v[60:63], v[152:167]
  ds_read_b128 v[204:207], v5 offset:8704
  v_exp_f32 v47, v47
  v_add_f32 v10, v10, v45
  v_cvt_pk_bf16_f32 v42, v44, v45
  s_waitcnt lgkmcnt(6)
  v_mfma_f32_32x32x16_bf16 v[56:71], v[24:27], v[72:75], 0
  s_barrier
  v_add_u32 v6, 65536, v6
  v_add_u32 v7, 65536, v7
  ds_read_b64_tr_b16 v[24:25], v6 offset:16384
  ds_read_b64_tr_b16 v[26:27], v6 offset:18432
  v_exp_f32 v48, v48
  v_add_f32 v9, v9, v46
  v_exp_f32 v49, v49
  v_mfma_f32_32x32x16_bf16 v[56:71], v[28:31], v[76:79], v[56:71]
  ds_read_b64_tr_b16 v[28:29], v7 offset:16384
  ds_read_b64_tr_b16 v[30:31], v7 offset:18432
  v_add_f32 v10, v10, v47
  v_cvt_pk_bf16_f32 v43, v46, v47
  v_exp_f32 v50, v50
  s_waitcnt lgkmcnt(8)
  v_mfma_f32_32x32x16_bf16 v[56:71], v[32:35], v[80:83], v[56:71]
  ds_read_b64_tr_b16 v[32:33], v6 offset:16896
  ds_read_b64_tr_b16 v[34:35], v6 offset:18944
  v_add_f32 v9, v9, v48
  v_exp_f32 v51, v51
  v_add_f32 v10, v10, v49
  v_mfma_f32_32x32x16_bf16 v[56:71], v[36:39], v[84:87], v[56:71]
  ds_read_b64_tr_b16 v[36:37], v7 offset:16896
  ds_read_b64_tr_b16 v[38:39], v7 offset:18944
  v_cvt_pk_bf16_f32 v44, v48, v49
  v_exp_f32 v52, v52
  v_add_f32 v9, v9, v50
  s_waitcnt lgkmcnt(10)
  v_mfma_f32_32x32x16_bf16 v[56:71], v[16:19], v[88:91], v[56:71]
  ds_read_b64_tr_b16 v[16:17], v6 offset:20480
  ds_read_b64_tr_b16 v[18:19], v6 offset:22528
  v_exp_f32 v53, v53
  v_add_f32 v10, v10, v51
  v_cvt_pk_bf16_f32 v45, v50, v51
  v_mfma_f32_32x32x16_bf16 v[56:71], v[20:23], v[92:95], v[56:71]
  ds_read_b64_tr_b16 v[20:21], v7 offset:20480
  ds_read_b64_tr_b16 v[22:23], v7 offset:22528
  v_exp_f32 v54, v54
  v_add_f32 v9, v9, v52
  v_exp_f32 v55, v55
  s_waitcnt lgkmcnt(12)
  v_mfma_f32_32x32x16_bf16 v[56:71], v[200:203], v[96:99], v[56:71]
  ds_read_b64_tr_b16 v[200:201], v6 offset:20992
  ds_read_b64_tr_b16 v[202:203], v6 offset:23040
  v_add_f32 v10, v10, v53
  v_cvt_pk_bf16_f32 v46, v52, v53
  v_add_f32 v9, v9, v54
  v_mfma_f32_32x32x16_bf16 v[56:71], v[204:207], v[100:103], v[56:71]
  v_add_f32 v10, v10, v55
  v_cvt_pk_bf16_f32 v47, v54, v55
  s_waitcnt lgkmcnt(10)
  v_mfma_f32_32x32x16_bf16 v[104:119], v[24:27], v[40:43], v[104:119]
  ds_read_b64_tr_b16 v[204:205], v7 offset:20992
  ds_read_b64_tr_b16 v[206:207], v7 offset:23040
  s_barrier
  ds_read_b128 v[24:27], v2 offset:32768
  v_mfma_f32_32x32x16_bf16 v[120:135], v[28:31], v[40:43], v[120:135]
  ds_read_b128 v[28:31], v3 offset:32768
  s_nop 1
  v_max3_f32 v15, v56, v57, v58
  v_max3_f32 v1, v59, v60, v61
  v_max3_f32 v15, v15, v62, v63
  v_max3_f32 v1, v1, v64, v65
  v_max3_f32 v15, v15, v66, v67
  s_waitcnt lgkmcnt(10)
  v_mfma_f32_32x32x16_bf16 v[136:151], v[32:35], v[40:43], v[136:151]
  ds_read_b128 v[32:35], v4 offset:32768
  v_max3_f32 v1, v1, v68, v69
  v_max3_f32 v15, v15, v70, v71
  v_max_f32 v15, v15, v1
  v_cmp_nge_f32 vcc, s67, v15
  v_mfma_f32_32x32x16_bf16 v[152:167], v[36:39], v[40:43], v[152:167]
  s_cbranch_vccnz L_A_stub13
L_A_back13:
  v_exp_f32 v56, v56
  ds_read_b128 v[36:39], v5 offset:32768
  v_exp_f32 v57, v57
  v_exp_f32 v58, v58
  v_add_f32 v9, v9, v56
  s_waitcnt lgkmcnt(8)
  v_mfma_f32_32x32x16_bf16 v[104:119], v[16:19], v[44:47], v[104:119]
  ds_read_b128 v[16:19], v2 offset:33280
  v_exp_f32 v59, v59
  v_add_f32 v10, v10, v57
  v_cvt_pk_bf16_f32 v56, v56, v57
  v_exp_f32 v60, v60
  v_mfma_f32_32x32x16_bf16 v[120:135], v[20:23], v[44:47], v[120:135]
  ds_read_b128 v[20:23], v3 offset:33280
  v_add_f32 v9, v9, v58
  v_exp_f32 v61, v61
  v_add_f32 v10, v10, v59
  s_waitcnt lgkmcnt(6)
  v_mfma_f32_32x32x16_bf16 v[136:151], v[200:203], v[44:47], v[136:151]
  ds_read_b128 v[200:203], v4 offset:33280
  v_cvt_pk_bf16_f32 v57, v58, v59
  v_exp_f32 v62, v62
  v_add_f32 v9, v9, v60
  v_mfma_f32_32x32x16_bf16 v[152:167], v[204:207], v[44:47], v[152:167]
  ds_read_b128 v[204:207], v5 offset:33280
  v_exp_f32 v63, v63
  v_add_f32 v10, v10, v61
  v_cvt_pk_bf16_f32 v58, v60, v61
  s_waitcnt lgkmcnt(6)
  v_mfma_f32_32x32x16_bf16 v[40:55], v[24:27], v[72:75], 0
  ds_read_b64_tr_b16 v[24:25], v6 offset:24576
  ds_read_b64_tr_b16 v[26:27], v6 offset:26624
  v_exp_f32 v64, v64
  v_add_f32 v9, v9, v62
  v_exp_f32 v65, v65
  v_mfma_f32_32x32x16_bf16 v[40:55], v[28:31], v[76:79], v[40:55]
  ds_read_b64_tr_b16 v[28:29], v7 offset:24576
  ds_read_b64_tr_b16 v[30:31], v7 offset:26624
  v_add_f32 v10, v10, v63
  v_cvt_pk_bf16_f32 v59, v62, v63
  v_exp_f32 v66, v66
  s_waitcnt lgkmcnt(8)
  v_mfma_f32_32x32x16_bf16 v[40:55], v[32:35], v[80:83], v[40:55]
  ds_read_b64_tr_b16 v[32:33], v6 offset:25088
  ds_read_b64_tr_b16 v[34:35], v6 offset:27136
  v_add_f32 v9, v9, v64
  v_exp_f32 v67, v67
  v_add_f32 v10, v10, v65
  v_mfma_f32_32x32x16_bf16 v[40:55], v[36:39], v[84:87], v[40:55]
  ds_read_b64_tr_b16 v[36:37], v7 offset:25088
  ds_read_b64_tr_b16 v[38:39], v7 offset:27136
  v_cvt_pk_bf16_f32 v60, v64, v65
  v_exp_f32 v68, v68
  v_add_f32 v9, v9, v66
  s_waitcnt lgkmcnt(10)
  v_mfma_f32_32x32x16_bf16 v[40:55], v[16:19], v[88:91], v[40:55]
  ds_read_b64_tr_b16 v[16:17], v6 offset:28672
  ds_read_b64_tr_b16 v[18:19], v6 offset:30720
  v_exp_f32 v69, v69
  v_add_f32 v10, v10, v67
  v_cvt_pk_bf16_f32 v61, v66, v67
  v_mfma_f32_32x32x16_bf16 v[40:55], v[20:23], v[92:95], v[40:55]
  ds_read_b64_tr_b16 v[20:21], v7 offset:28672
  ds_read_b64_tr_b16 v[22:23], v7 offset:30720
  v_exp_f32 v70, v70
  v_add_f32 v9, v9, v68
  v_exp_f32 v71, v71
  s_waitcnt lgkmcnt(12)
  v_mfma_f32_32x32x16_bf16 v[40:55], v[200:203], v[96:99], v[40:55]
  ds_read_b64_tr_b16 v[200:201], v6 offset:29184
  ds_read_b64_tr_b16 v[202:203], v6 offset:31232
  v_add_f32 v10, v10, v69
  v_cvt_pk_bf16_f32 v62, v68, v69
  v_add_f32 v9, v9, v70
  v_mfma_f32_32x32x16_bf16 v[40:55], v[204:207], v[100:103], v[40:55]
  v_add_f32 v10, v10, v71
  v_cvt_pk_bf16_f32 v63, v70, v71
  s_waitcnt lgkmcnt(10)
  v_mfma_f32_32x32x16_bf16 v[104:119], v[24:27], v[56:59], v[104:119]
  ds_read_b64_tr_b16 v[204:205], v7 offset:29184
  ds_read_b64_tr_b16 v[206:207], v7 offset:31232
  ds_read_b128 v[24:27], v2 offset:40960
  v_mfma_f32_32x32x16_bf16 v[120:135], v[28:31], v[56:59], v[120:135]
  ds_read_b128 v[28:31], v3 offset:40960
  s_nop 2
  v_max3_f32 v15, v40, v41, v42
  v_max3_f32 v1, v43, v44, v45
  v_max3_f32 v15, v15, v46, v47
  v_max3_f32 v1, v1, v48, v49
  v_max3_f32 v15, v15, v50, v51
  s_waitcnt lgkmcnt(10)
  v_mfma_f32_32x32x16_bf16 v[136:151], v[32:35], v[56:59], v[136:151]
  ds_read_b128 v[32:35], v4 offset:40960
  v_max3_f32 v1, v1, v52, v53
  v_max3_f32 v15, v15, v54, v55
  v_max_f32 v15, v15, v1
  v_cmp_nge_f32 vcc, s67, v15
  v_mfma_f32_32x32x16_bf16 v[152:167], v[36:39], v[56:59], v[152:167]
  s_cbranch_vccnz L_A_stub14
L_A_back14:
  v_exp_f32 v40, v40
  ds_read_b128 v[36:39], v5 offset:40960
  v_exp_f32 v41, v41
  v_exp_f32 v42, v42
  v_add_f32 v9, v9, v40
  s_waitcnt lgkmcnt(8)
  v_mfma_f32_32x32x16_bf16 v[104:119], v[16:19], v[60:63], v[104:119]
  ds_read_b128 v[16:19], v2 offset:41472
  v_exp_f32 v43, v43
  v_add_f32 v10, v10, v41
  v_cvt_pk_bf16_f32 v40, v40, v41
  v_exp_f32 v44, v44
  v_mfma_f32_32x32x16_bf16 v[120:135], v[20:23], v[60:63], v[120:135]
  ds_read_b128 v[20:23], v3 offset:41472
  v_add_f32 v9, v9, v42
  v_exp_f32 v45, v45
  v_add_f32 v10, v10, v43
  s_waitcnt lgkmcnt(6)
  v_mfma_f32_32x32x16_bf16 v[136:151], v[200:203], v[60:63], v[136:151]
  ds_read_b128 v[200:203], v4 offset:41472
  v_cvt_pk_bf16_f32 v41, v42, v43
  v_exp_f32 v46, v46
  v_add_f32 v9, v9, v44
  v_mfma_f32_32x32x16_bf16 v[152:167], v[204:207], v[60:63], v[152:167]
  ds_read_b128 v[204:207], v5 offset:41472
  v_exp_f32 v47, v47
  v_add_f32 v10, v10, v45
  v_cvt_pk_bf16_f32 v42, v44, v45
  s_waitcnt lgkmcnt(6)
  v_mfma_f32_32x32x16_bf16 v[56:71], v[24:27], v[72:75], 0
  s_barrier
  v_subrev_u32 v6, 65536, v6
  v_subrev_u32 v7, 65536, v7
  ds_read_b64_tr_b16 v[24:25], v6 offset:0
  ds_read_b64_tr_b16 v[26:27], v6 offset:2048
  v_exp_f32 v48, v48
  v_add_f32 v9, v9, v46
  v_exp_f32 v49, v49
  v_mfma_f32_32x32x16_bf16 v[56:71], v[28:31], v[76:79], v[56:71]
  ds_read_b64_tr_b16 v[28:29], v7 offset:0
  ds_read_b64_tr_b16 v[30:31], v7 offset:2048
  v_add_f32 v10, v10, v47
  v_cvt_pk_bf16_f32 v43, v46, v47
  v_exp_f32 v50, v50
  s_waitcnt lgkmcnt(8)
  v_mfma_f32_32x32x16_bf16 v[56:71], v[32:35], v[80:83], v[56:71]
  ds_read_b64_tr_b16 v[32:33], v6 offset:512
  ds_read_b64_tr_b16 v[34:35], v6 offset:2560
  v_add_f32 v9, v9, v48
  v_exp_f32 v51, v51
  v_add_f32 v10, v10, v49
  v_mfma_f32_32x32x16_bf16 v[56:71], v[36:39], v[84:87], v[56:71]
  ds_read_b64_tr_b16 v[36:37], v7 offset:512
  ds_read_b64_tr_b16 v[38:39], v7 offset:2560
  v_cvt_pk_bf16_f32 v44, v48, v49
  v_exp_f32 v52, v52
  v_add_f32 v9, v9, v50
  s_waitcnt lgkmcnt(10)
  v_mfma_f32_32x32x16_bf16 v[56:71], v[16:19], v[88:91], v[56:71]
  ds_read_b64_tr_b16 v[16:17], v6 offset:4096
  ds_read_b64_tr_b16 v[18:19], v6 offset:6144
  v_exp_f32 v53, v53
  v_add_f32 v10, v10, v51
  v_cvt_pk_bf16_f32 v45, v50, v51
  v_mfma_f32_32x32x16_bf16 v[56:71], v[20:23], v[92:95], v[56:71]
  ds_read_b64_tr_b16 v[20:21], v7 offset:4096
  ds_read_b64_tr_b16 v[22:23], v7 offset:6144
  v_exp_f32 v54, v54
  v_add_f32 v9, v9, v52
  v_exp_f32 v55, v55
  s_waitcnt lgkmcnt(12)
  v_mfma_f32_32x32x16_bf16 v[56:71], v[200:203], v[96:99], v[56:71]
  ds_read_b64_tr_b16 v[200:201], v6 offset:4608
  ds_read_b64_tr_b16 v[202:203], v6 offset:6656
  v_add_f32 v10, v10, v53
  v_cvt_pk_bf16_f32 v46, v52, v53
  v_add_f32 v9, v9, v54
  v_mfma_f32_32x32x16_bf16 v[56:71], v[204:207], v[100:103], v[56:71]
  v_add_f32 v10, v10, v55
  v_cvt_pk_bf16_f32 v47, v54, v55
  s_waitcnt lgkmcnt(10)
  v_mfma_f32_32x32x16_bf16 v[104:119], v[24:27], v[40:43], v[104:119]
  ds_read_b64_tr_b16 v[204:205], v7 offset:4608
  ds_read_b64_tr_b16 v[206:207], v7 offset:6656
  ds_read_b64_tr_b16 v[24:25], v6 offset:8192
  ds_read_b64_tr_b16 v[26:27], v6 offset:10240
  v_mfma_f32_32x32x16_bf16 v[120:135], v[28:31], v[40:43], v[120:135]
  s_nop 2
  v_max3_f32 v15, v56, v57, v58
  v_max3_f32 v1, v59, v60, v61
  v_max3_f32 v15, v15, v62, v63
  v_max3_f32 v1, v1, v64, v65
  v_max3_f32 v15, v15, v66, v67
  v_max3_f32 v1, v1, v68, v69
  v_max3_f32 v15, v15, v70, v71
  v_max_f32 v15, v15, v1
  v_cmp_nge_f32 vcc, s67, v15
  s_waitcnt lgkmcnt(10)
  v_mfma_f32_32x32x16_bf16 v[136:151], v[32:35], v[40:43], v[136:151]
  s_cbranch_vccnz L_A_stub15
L_A_back15:
  v_exp_f32 v56, v56
  ds_read_b64_tr_b16 v[28:29], v7 offset:8192
  ds_read_b64_tr_b16 v[30:31], v7 offset:10240
  ds_read_b64_tr_b16 v[32:33], v6 offset:8704
  ds_read_b64_tr_b16 v[34:35], v6 offset:10752
  v_exp_f32 v57, v57
  v_exp_f32 v58, v58
  v_add_f32 v9, v9, v56
  v_exp_f32 v59, v59
  v_add_f32 v10, v10, v57
  v_cvt_pk_bf16_f32 v56, v56, v57
  v_mfma_f32_32x32x16_bf16 v[152:167], v[36:39], v[40:43], v[152:167]
  v_exp_f32 v60, v60
  v_add_f32 v9, v9, v58
  v_exp_f32 v61, v61
  v_add_f32 v10, v10, v59
  v_cvt_pk_bf16_f32 v57, v58, v59
  v_exp_f32 v62, v62
  s_waitcnt lgkmcnt(10)
  v_mfma_f32_32x32x16_bf16 v[104:119], v[16:19], v[44:47], v[104:119]
  ds_read_b64_tr_b16 v[36:37], v7 offset:8704
  ds_read_b64_tr_b16 v[38:39], v7 offset:10752
  ds_read_b64_tr_b16 v[16:17], v6 offset:12288
  ds_read_b64_tr_b16 v[18:19], v6 offset:14336
  v_add_f32 v9, v9, v60
  v_exp_f32 v63, v63
  v_add_f32 v10, v10, v61
  v_cvt_pk_bf16_f32 v58, v60, v61
  v_exp_f32 v64, v64
  v_add_f32 v9, v9, v62
  v_exp_f32 v65, v65
  v_mfma_f32_32x32x16_bf16 v[120:135], v[20:23], v[44:47], v[120:135]
  v_add_f32 v10, v10, v63
  v_cvt_pk_bf16_f32 v59, v62, v63
  v_exp_f32 v66, v66
  v_add_f32 v9, v9, v64
  v_exp_f32 v67, v67
  v_add_f32 v10, v10, v65
  v_cvt_pk_bf16_f32 v60, v64, v65
  s_waitcnt lgkmcnt(10)
  v_mfma_f32_32x32x16_bf16 v[136:151], v[200:203], v[44:47], v[136:151]
  ds_read_b64_tr_b16 v[20:21], v7 offset:12288
  ds_read_b64_tr_b16 v[22:23], v7 offset:14336
  ds_read_b64_tr_b16 v[200:201], v6 offset:12800
  ds_read_b64_tr_b16 v[202:203], v6 offset:14848
  v_exp_f32 v68, v68
  v_add_f32 v9, v9, v66
  v_exp_f32 v69, v69
  v_add_f32 v10, v10, v67
  v_cvt_pk_bf16_f32 v61, v66, v67
  v_exp_f32 v70, v70
  v_mfma_f32_32x32x16_bf16 v[152:167], v[204:207], v[44:47], v[152:167]
  v_add_f32 v9, v9, v68
  v_exp_f32 v71, v71
  v_add_f32 v10, v10, v69
  v_cvt_pk_bf16_f32 v62, v68, v69
  v_add_f32 v9, v9, v70
  v_add_f32 v10, v10, v71
  v_cvt_pk_bf16_f32 v63, v70, v71
  s_waitcnt lgkmcnt(10)
  v_mfma_f32_32x32x16_bf16 v[104:119], v[24:27], v[56:59], v[104:119]
  ds_read_b64_tr_b16 v[204:205], v7 offset:12800
  ds_read_b64_tr_b16 v[206:207], v7 offset:14848
  s_cmp_eq_u32 s58, 1
  s_cbranch_scc1 L_A_nobar
  s_barrier
L_A_nobar:
  ds_read_b128 v[24:27], v2 offset:49152
  v_mfma_f32_32x32x16_bf16 v[120:135], v[28:31], v[56:59], v[120:135]
  ds_read_b128 v[28:31], v3 offset:49152
  v_add_f32 v9, v9, v10
  v_mov_b32 v1, v9
  s_nop 1
  v_permlane32_swap_b32 v1, v9
  v_add_f32 v9, v9, v1
  v_rcp_f32 v8, v9
  s_waitcnt lgkmcnt(10)
  v_mfma_f32_32x32x16_bf16 v[136:151], v[32:35], v[56:59], v[136:151]
  ds_read_b128 v[32:35], v4 offset:49152
  v_mov_b32 v72, v168
  v_mov_b32 v73, v169
  v_mov_b32 v74, v170
  v_mov_b32 v75, v171
  v_mov_b32 v76, v172
  v_mov_b32 v77, v173
  v_mfma_f32_32x32x16_bf16 v[152:167], v[36:39], v[56:59], v[152:167]
  ds_read_b128 v[36:39], v5 offset:49152
  v_mov_b32 v78, v174
  v_mov_b32 v79, v175
  v_mov_b32 v80, v176
  v_mov_b32 v81, v177
  v_mov_b32 v82, v178
  v_mov_b32 v83, v179
  s_waitcnt lgkmcnt(8)
  v_mfma_f32_32x32x16_bf16 v[104:119], v[16:19], v[60:63], v[104:119]
  ds_read_b128 v[16:19], v2 offset:49664
  v_mov_b32 v84, v180
  v_mov_b32 v85, v181
  v_mov_b32 v86, v182
  v_mov_b32 v87, v183
  v_mov_b32 v88, v184
  v_mov_b32 v89, v185
  v_mfma_f32_32x32x16_bf16 v[120:135], v[20:23], v[60:63], v[120:135]
  ds_read_b128 v[20:23], v3 offset:49664
  v_mov_b32 v90, v186
  v_mov_b32 v91, v187
  v_mov_b32 v92, v188
  v_mov_b32 v93, v189
  v_mov_b32 v94, v190
  v_mov_b32 v95, v191
  s_waitcnt lgkmcnt(6)
  v_mfma_f32_32x32x16_bf16 v[136:151], v[200:203], v[60:63], v[136:151]
  ds_read_b128 v[200:203], v4 offset:49664
  v_mov_b32 v96, v192
  v_mov_b32 v97, v193
  v_mov_b32 v98, v194
  v_mov_b32 v99, v195
  v_mov_b32 v100, v196
  v_mov_b32 v101, v197
  v_mfma_f32_32x32x16_bf16 v[152:167], v[204:207], v[60:63], v[152:167]
  ds_read_b128 v[204:207], v5 offset:49664
  v_mov_b32 v102, v198
  v_mov_b32 v103, v199
  s_cmp_eq_u32 s58, 1
  s_cbranch_scc1 L_A_tail
  s_waitcnt lgkmcnt(6)
  v_mfma_f32_32x32x16_bf16 v[40:55], v[24:27], v[72:75], 0
  ds_read_b128 v[24:27], v2 offset:57344
  v_mfma_f32_32x32x16_bf16 v[40:55], v[28:31], v[76:79], v[40:55]
  ds_read_b128 v[28:31], v3 offset:57344
  v_mul_f32 v104, v8, v104
  v_mul_f32 v105, v8, v105
  v_mul_f32 v106, v8, v106
  v_mul_f32 v107, v8, v107
  v_mul_f32 v108, v8, v108
  v_mul_f32 v109, v8, v109
  v_mul_f32 v110, v8, v110
  v_mul_f32 v111, v8, v111
  v_cvt_pk_bf16_f32 v104, v104, v105
  v_cvt_pk_bf16_f32 v105, v106, v107
  v_cvt_pk_bf16_f32 v106, v108, v109
  v_cvt_pk_bf16_f32 v107, v110, v111
  s_add_u32 s38, s62, 0
  buffer_store_dwordx4 v[104:107], v14, s[32:35], s38 offen offset:0 sc1
  v_mul_f32 v112, v8, v112
  v_mul_f32 v113, v8, v113
  s_waitcnt lgkmcnt(6)
  v_mfma_f32_32x32x16_bf16 v[40:55], v[32:35], v[80:83], v[40:55]
  ds_read_b128 v[32:35], v4 offset:57344
  v_mul_f32 v114, v8, v114
  v_mul_f32 v115, v8, v115
  v_mul_f32 v116, v8, v116
  v_mul_f32 v117, v8, v117
  v_mul_f32 v118, v8, v118
  v_mul_f32 v119, v8, v119
  v_cvt_pk_bf16_f32 v112, v112, v113
  v_cvt_pk_bf16_f32 v113, v114, v115
  v_cvt_pk_bf16_f32 v114, v116, v117
  v_cvt_pk_bf16_f32 v115, v118, v119
  buffer_store_dwordx4 v[112:115], v14, s[32:35], s38 offen offset:1024 sc1
  v_mul_f32 v120, v8, v120
  v_mul_f32 v121, v8, v121
  v_mul_f32 v122, v8, v122
  v_mul_f32 v123, v8, v123
  v_mul_f32 v124, v8, v124
  v_mfma_f32_32x32x16_bf16 v[40:55], v[36:39], v[84:87], v[40:55]
  ds_read_b128 v[36:39], v5 offset:57344
  v_mul_f32 v125, v8, v125
  v_mul_f32 v126, v8, v126
  v_mul_f32 v127, v8, v127
  v_cvt_pk_bf16_f32 v120, v120, v121
  v_cvt_pk_bf16_f32 v121, v122, v123
  v_cvt_pk_bf16_f32 v122, v124, v125
  v_cvt_pk_bf16_f32 v123, v126, v127
  buffer_store_dwordx4 v[120:123], v14, s[32:35], s38 offen offset:2048 sc1
  v_mul_f32 v128, v8, v128
  v_mul_f32 v129, v8, v129
  v_mul_f32 v130, v8, v130
  v_mul_f32 v131, v8, v131
  v_mul_f32 v132, v8, v132
  v_mul_f32 v133, v8, v133
  v_mul_f32 v134, v8, v134
  v_mul_f32 v135, v8, v135
  s_waitcnt lgkmcnt(6)
  v_mfma_f32_32x32x16_bf16 v[40:55], v[16:19], v[88:91], v[40:55]
  ds_read_b128 v[16:19], v2 offset:57856
  v_cvt_pk_bf16_f32 v128, v128, v129
  v_cvt_pk_bf16_f32 v129, v130, v131
  v_cvt_pk_bf16_f32 v130, v132, v133
  v_cvt_pk_bf16_f32 v131, v134, v135
  buffer_store_dwordx4 v[128:131], v14, s[32:35], s38 offen offset:3072 sc1
  v_mul_f32 v136, v8, v136
  v_mul_f32 v137, v8, v137
  v_mul_f32 v138, v8, v138
  v_mul_f32 v139, v8, v139
  v_mul_f32 v140, v8, v140
  v_mul_f32 v141, v8, v141
  v_mul_f32 v142, v8, v142
  v_mul_f32 v143, v8, v143
  v_cvt_pk_bf16_f32 v136, v136, v137
  v_cvt_pk_bf16_f32 v137, v138, v139
  v_cvt_pk_bf16_f32 v138, v140, v141
  v_mfma_f32_32x32x16_bf16 v[40:55], v[20:23], v[92:95], v[40:55]
  ds_read_b128 v[20:23], v3 offset:57856
  v_cvt_pk_bf16_f32 v139, v142, v143
  s_add_u32 s38, s62, 16384
  buffer_store_dwordx4 v[136:139], v14, s[32:35], s38 offen offset:0 sc1
  v_mul_f32 v144, v8, v144
  v_mul_f32 v145, v8, v145
  v_mul_f32 v146, v8, v146
  v_mul_f32 v147, v8, v147
  v_mul_f32 v148, v8, v148
  v_mul_f32 v149, v8, v149
  v_mul_f32 v150, v8, v150
  v_mul_f32 v151, v8, v151
  v_cvt_pk_bf16_f32 v144, v144, v145
  v_cvt_pk_bf16_f32 v145, v146, v147
  v_cvt_pk_bf16_f32 v146, v148, v149
  v_cvt_pk_bf16_f32 v147, v150, v151
  buffer_store_dwordx4 v[144:147], v14, s[32:35], s38 offen offset:1024 sc1
  s_waitcnt lgkmcnt(6)
  v_mfma_f32_32x32x16_bf16 v[40:55], v[200:203], v[96:99], v[40:55]
  v_mul_f32 v152, v8, v152
  v_mul_f32 v153, v8, v153
  v_mul_f32 v154, v8, v154
  v_mul_f32 v155, v8, v155
  v_mul_f32 v156, v8, v156
  v_mul_f32 v157, v8, v157
  v_mul_f32 v158, v8, v158
  v_mul_f32 v159, v8, v159
  v_cvt_pk_bf16_f32 v152, v152, v153
  v_cvt_pk_bf16_f32 v153, v154, v155
  v_cvt_pk_bf16_f32 v154, v156, v157
  v_cvt_pk_bf16_f32 v155, v158, v159
  buffer_store_dwordx4 v[152:155], v14, s[32:35], s38 offen offset:2048 sc1
  v_mul_f32 v160, v8, v160
  v_mul_f32 v161, v8, v161
  v_mul_f32 v162, v8, v162
  v_mfma_f32_32x32x16_bf16 v[40:55], v[204:207], v[100:103], v[40:55]
  v_mul_f32 v163, v8, v163
  v_mul_f32 v164, v8, v164
  v_mul_f32 v165, v8, v165
  v_mul_f32 v166, v8, v166
  v_mul_f32 v167, v8, v167
  v_cvt_pk_bf16_f32 v160, v160, v161
  v_cvt_pk_bf16_f32 v161, v162, v163
  v_cvt_pk_bf16_f32 v162, v164, v165
  v_cvt_pk_bf16_f32 v163, v166, v167
  buffer_store_dwordx4 v[160:163], v14, s[32:35], s38 offen offset:3072 sc1
  s_xor_b32 s62, s62, 131072
  s_mov_b32 s58, 1
  s_mov_b32 s10, s34
  s_mov_b32 s43, 99
  v_lshrrev_b32 v240, 3, v0
  v_and_b32 v241, 7, v0
  v_bfe_u32 v242, v0, 4, 1
  v_lshrrev_b32 v243, 4, v0
  v_bfe_u32 v244, v0, 3, 2
  v_lshrrev_b32 v245, 5, v0
  v_lshlrev_b32 v246, 2, v242
  v_xor_b32 v246, v246, v241
  v_lshlrev_b32 v246, 4, v246
  v_lshl_add_u32 v247, v244, 10, v246
  v_lshl_add_u32 v247, v245, 7, v247
  s_lshl_b32 s38, s47, 14
  v_add_u32 v247, s38, v247
  v_add_u32 v232, 0, v247
  v_add_u32 v233, 3072, v247
  v_add_u32 v234, 6144, v247
  v_add_u32 v235, 9216, v247
  v_lshlrev_b32 v236, 4, v0
  v_and_b32 v247, 3, v0
  v_lshlrev_b32 v237, 2, v247
  s_waitcnt lgkmcnt(0)
  s_nop 0
  s_branch L_A_head
L_A_tail:
  s_nop 11
  v_mul_f32 v104, v8, v104
  v_mul_f32 v105, v8, v105
  v_mul_f32 v106, v8, v106
  v_mul_f32 v107, v8, v107
  v_mul_f32 v108, v8, v108
  v_mul_f32 v109, v8, v109
  v_mul_f32 v110, v8, v110
  v_mul_f32 v111, v8, v111
  v_cvt_pk_bf16_f32 v104, v104, v105
  v_cvt_pk_bf16_f32 v105, v106, v107
  v_cvt_pk_bf16_f32 v106, v108, v109
  v_cvt_pk_bf16_f32 v107, v110, v111
  s_add_u32 s38, s62, 0
  buffer_store_dwordx4 v[104:107], v14, s[32:35], s38 offen offset:0 sc1
  v_mul_f32 v112, v8, v112
  v_mul_f32 v113, v8, v113
  v_mul_f32 v114, v8, v114
  v_mul_f32 v115, v8, v115
  v_mul_f32 v116, v8, v116
  v_mul_f32 v117, v8, v117
  v_mul_f32 v118, v8, v118
  v_mul_f32 v119, v8, v119
  v_cvt_pk_bf16_f32 v112, v112, v113
  v_cvt_pk_bf16_f32 v113, v114, v115
  v_cvt_pk_bf16_f32 v114, v116, v117
  v_cvt_pk_bf16_f32 v115, v118, v119
  buffer_store_dwordx4 v[112:115], v14, s[32:35], s38 offen offset:1024 sc1
  v_mul_f32 v120, v8, v120
  v_mul_f32 v121, v8, v121
  v_mul_f32 v122, v8, v122
  v_mul_f32 v123, v8, v123
  v_mul_f32 v124, v8, v124
  v_mul_f32 v125, v8, v125
  v_mul_f32 v126, v8, v126
  v_mul_f32 v127, v8, v127
  v_cvt_pk_bf16_f32 v120, v120, v121
  v_cvt_pk_bf16_f32 v121, v122, v123
  v_cvt_pk_bf16_f32 v122, v124, v125
  v_cvt_pk_bf16_f32 v123, v126, v127
  buffer_store_dwordx4 v[120:123], v14, s[32:35], s38 offen offset:2048 sc1
  v_mul_f32 v128, v8, v128
  v_mul_f32 v129, v8, v129
  v_mul_f32 v130, v8, v130
  v_mul_f32 v131, v8, v131
  v_mul_f32 v132, v8, v132
  v_mul_f32 v133, v8, v133
  v_mul_f32 v134, v8, v134
  v_mul_f32 v135, v8, v135
  v_cvt_pk_bf16_f32 v128, v128, v129
  v_cvt_pk_bf16_f32 v129, v130, v131
  v_cvt_pk_bf16_f32 v130, v132, v133
  v_cvt_pk_bf16_f32 v131, v134, v135
  buffer_store_dwordx4 v[128:131], v14, s[32:35], s38 offen offset:3072 sc1
  v_mul_f32 v136, v8, v136
  v_mul_f32 v137, v8, v137
  v_mul_f32 v138, v8, v138
  v_mul_f32 v139, v8, v139
  v_mul_f32 v140, v8, v140
  v_mul_f32 v141, v8, v141
  v_mul_f32 v142, v8, v142
  v_mul_f32 v143, v8, v143
  v_cvt_pk_bf16_f32 v136, v136, v137
  v_cvt_pk_bf16_f32 v137, v138, v139
  v_cvt_pk_bf16_f32 v138, v140, v141
  v_cvt_pk_bf16_f32 v139, v142, v143
  s_add_u32 s38, s62, 16384
  buffer_store_dwordx4 v[136:139], v14, s[32:35], s38 offen offset:0 sc1
  v_mul_f32 v144, v8, v144
  v_mul_f32 v145, v8, v145
  v_mul_f32 v146, v8, v146
  v_mul_f32 v147, v8, v147
  v_mul_f32 v148, v8, v148
  v_mul_f32 v149, v8, v149
  v_mul_f32 v150, v8, v150
  v_mul_f32 v151, v8, v151
  v_cvt_pk_bf16_f32 v144, v144, v145
  v_cvt_pk_bf16_f32 v145, v146, v147
  v_cvt_pk_bf16_f32 v146, v148, v149
  v_cvt_pk_bf16_f32 v147, v150, v151
  buffer_store_dwordx4 v[144:147], v14, s[32:35], s38 offen offset:1024 sc1
  v_mul_f32 v152, v8, v152
  v_mul_f32 v153, v8, v153
  v_mul_f32 v154, v8, v154
  v_mul_f32 v155, v8, v155
  v_mul_f32 v156, v8, v156
  v_mul_f32 v157, v8, v157
  v_mul_f32 v158, v8, v158
  v_mul_f32 v159, v8, v159
  v_cvt_pk_bf16_f32 v152, v152, v153
  v_cvt_pk_bf16_f32 v153, v154, v155
  v_cvt_pk_bf16_f32 v154, v156, v157
  v_cvt_pk_bf16_f32 v155, v158, v159
  buffer_store_dwordx4 v[152:155], v14, s[32:35], s38 offen offset:2048 sc1
  v_mul_f32 v160, v8, v160
  v_mul_f32 v161, v8, v161
  v_mul_f32 v162, v8, v162
  v_mul_f32 v163, v8, v163
  v_mul_f32 v164, v8, v164
  v_mul_f32 v165, v8, v165
  v_mul_f32 v166, v8, v166
  v_mul_f32 v167, v8, v167
  v_cvt_pk_bf16_f32 v160, v160, v161
  v_cvt_pk_bf16_f32 v161, v162, v163
  v_cvt_pk_bf16_f32 v162, v164, v165
  v_cvt_pk_bf16_f32 v163, v166, v167
  buffer_store_dwordx4 v[160:163], v14, s[32:35], s38 offen offset:3072 sc1
  s_nop 1
  s_barrier
  s_add_u32 s39, s71, 2
  s_and_b32 s39, s39, 7
  s_xor_b32 s39, s39, s99
  s_lshl_b32 s54, s39, 14
  s_add_u32 s54, s54, s50
  s_add_u32 m0, s68, 49152
  s_nop 0
  buffer_load_dwordx4 v236, s[32:35], s54 offen offset:0 sc1 lds
  buffer_load_dwordx4 v236, s[32:35], s54 offen offset:1024 sc1 lds
  buffer_load_dwordx4 v236, s[32:35], s54 offen offset:2048 sc1 lds
  buffer_load_dwordx4 v236, s[32:35], s54 offen offset:3072 sc1 lds
  s_add_u32 s39, s71, 3
  s_and_b32 s39, s39, 7
  s_xor_b32 s39, s39, s99
  s_lshl_b32 s54, s39, 16
  s_add_u32 s54, s54, s49
  s_add_u32 m0, s68, 65536
  s_nop 0
  buffer_load_dwordx4 v232, s[24:27], s54 offen offset:0  lds
  buffer_load_dwordx4 v233, s[24:27], s54 offen offset:1024  lds
  buffer_load_dwordx4 v234, s[24:27], s54 offen offset:2048  lds
  buffer_load_dwordx4 v235, s[24:27], s54 offen offset:3072  lds
  s_add_u32 s39, s71, 3
  s_and_b32 s39, s39, 7
  s_xor_b32 s39, s39, s99
  s_lshl_b32 s54, s39, 14
  s_add_u32 s54, s54, s50
  s_add_u32 m0, s68, 81920
  s_nop 0
  buffer_load_dwordx4 v236, s[32:35], s54 offen offset:0 sc1 lds
  buffer_load_dwordx4 v236, s[32:35], s54 offen offset:1024 sc1 lds
  buffer_load_dwordx4 v236, s[32:35], s54 offen offset:2048 sc1 lds
  buffer_load_dwordx4 v236, s[32:35], s54 offen offset:3072 sc1 lds
  s_waitcnt vmcnt(12)
  s_add_u32 s38, s45, 1536
  v_mov_b32 v1, 1
  v_mov_b32 v15, 0
  s_mov_b64 s[52:53], exec
  s_mov_b64 exec, 1
  buffer_store_dword v1, v15, s[32:35], s38 offen sc1
  s_mov_b64 exec, s[52:53]
  s_barrier
  s_add_u32 s39, s71, 4
  s_and_b32 s39, s39, 7
  s_xor_b32 s39, s39, s99
  s_lshl_b32 s54, s39, 16
  s_add_u32 s54, s54, s49
  s_add_u32 m0, s68, 0
  s_nop 0
  buffer_load_dwordx4 v232, s[24:27], s54 offen offset:0  lds
  buffer_load_dwordx4 v233, s[24:27], s54 offen offset:1024  lds
  buffer_load_dwordx4 v234, s[24:27], s54 offen offset:2048  lds
  buffer_load_dwordx4 v235, s[24:27], s54 offen offset:3072  lds
  s_add_u32 s39, s71, 4
  s_and_b32 s39, s39, 7
  s_xor_b32 s39, s39, s99
  s_lshl_b32 s54, s39, 14
  s_add_u32 s54, s54, s50
  s_add_u32 m0, s68, 98304
  s_nop 0
  buffer_load_dwordx4 v236, s[32:35], s54 offen offset:0 sc1 lds
  buffer_load_dwordx4 v236, s[32:35], s54 offen offset:1024 sc1 lds
  buffer_load_dwordx4 v236, s[32:35], s54 offen offset:2048 sc1 lds
  buffer_load_dwordx4 v236, s[32:35], s54 offen offset:3072 sc1 lds
  s_waitcnt vmcnt(17)
  s_barrier
  s_add_u32 s39, s71, 5
  s_and_b32 s39, s39, 7
  s_xor_b32 s39, s39, s99
  s_lshl_b32 s54, s39, 16
  s_add_u32 s54, s54, s49
  s_add_u32 m0, s68, 16384
  s_nop 0
  buffer_load_dwordx4 v232, s[24:27], s54 offen offset:0  lds
  buffer_load_dwordx4 v233, s[24:27], s54 offen offset:1024  lds
  buffer_load_dwordx4 v234, s[24:27], s54 offen offset:2048  lds
  buffer_load_dwordx4 v235, s[24:27], s54 offen offset:3072  lds
  s_waitcnt vmcnt(13)
  s_barrier
  s_add_u32 s39, s71, 5
  s_and_b32 s39, s39, 7
  s_xor_b32 s39, s39, s99
  s_lshl_b32 s54, s39, 14
  s_add_u32 s54, s54, s50
  s_add_u32 m0, s68, 32768
  s_nop 0
  buffer_load_dwordx4 v236, s[32:35], s54 offen offset:0 sc1 lds
  buffer_load_dwordx4 v236, s[32:35], s54 offen offset:1024 sc1 lds
  buffer_load_dwordx4 v236, s[32:35], s54 offen offset:2048 sc1 lds
  buffer_load_dwordx4 v236, s[32:35], s54 offen offset:3072 sc1 lds
  s_add_u32 s39, s71, 6
  s_and_b32 s39, s39, 7
  s_xor_b32 s39, s39, s99
  s_lshl_b32 s54, s39, 16
  s_add_u32 s54, s54, s49
  s_add_u32 m0, s68, 114688
  s_nop 0
  buffer_load_dwordx4 v232, s[24:27], s54 offen offset:0  lds
  buffer_load_dwordx4 v233, s[24:27], s54 offen offset:1024  lds
  buffer_load_dwordx4 v234, s[24:27], s54 offen offset:2048  lds
  buffer_load_dwordx4 v235, s[24:27], s54 offen offset:3072  lds
  s_waitcnt vmcnt(12)
  s_barrier
  s_add_u32 s39, s71, 6
  s_and_b32 s39, s39, 7
  s_xor_b32 s39, s39, s99
  s_lshl_b32 s54, s39, 14
  s_add_u32 s54, s54, s50
  s_add_u32 m0, s68, 131072
  s_nop 0
  buffer_load_dwordx4 v236, s[32:35], s54 offen offset:0 sc1 lds
  buffer_load_dwordx4 v236, s[32:35], s54 offen offset:1024 sc1 lds
  buffer_load_dwordx4 v236, s[32:35], s54 offen offset:2048 sc1 lds
  buffer_load_dwordx4 v236, s[32:35], s54 offen offset:3072 sc1 lds
  s_add_u32 s39, s71, 7
  s_and_b32 s39, s39, 7
  s_xor_b32 s39, s39, s99
  s_lshl_b32 s54, s39, 16
  s_add_u32 s54, s54, s49
  s_add_u32 m0, s68, 49152
  s_nop 0
  buffer_load_dwordx4 v232, s[24:27], s54 offen offset:0  lds
  buffer_load_dwordx4 v233, s[24:27], s54 offen offset:1024  lds
  buffer_load_dwordx4 v234, s[24:27], s54 offen offset:2048  lds
  buffer_load_dwordx4 v235, s[24:27], s54 offen offset:3072  lds
  s_waitcnt vmcnt(12)
  s_barrier
  s_add_u32 s39, s71, 7
  s_and_b32 s39, s39, 7
  s_xor_b32 s39, s39, s99
  s_lshl_b32 s54, s39, 14
  s_add_u32 s54, s54, s50
  s_add_u32 m0, s68, 147456
  s_nop 0
  buffer_load_dwordx4 v236, s[32:35], s54 offen offset:0 sc1 lds
  buffer_load_dwordx4 v236, s[32:35], s54 offen offset:1024 sc1 lds
  buffer_load_dwordx4 v236, s[32:35], s54 offen offset:2048 sc1 lds
  buffer_load_dwordx4 v236, s[32:35], s54 offen offset:3072 sc1 lds
  s_add_u32 s39, s71, 8
  s_and_b32 s39, s39, 7
  s_add_u32 s39, s39, 8
  s_xor_b32 s39, s39, s99
  s_lshl_b32 s54, s39, 16
  s_add_u32 s54, s54, s49
  s_add_u32 m0, s68, 65536
  s_nop 0
  buffer_load_dwordx4 v232, s[24:27], s54 offen offset:0  lds
  buffer_load_dwordx4 v233, s[24:27], s54 offen offset:1024  lds
  buffer_load_dwordx4 v234, s[24:27], s54 offen offset:2048  lds
  buffer_load_dwordx4 v235, s[24:27], s54 offen offset:3072  lds
  s_add_u32 s38, s46, 1536
  buffer_load_dword v238, v237, s[32:35], s38 offen sc1
  s_waitcnt vmcnt(13)
  s_barrier
  s_waitcnt vmcnt(0)
  v_cmp_ne_u32 vcc, 1, v238
  s_cbranch_vccz L_ok_a2c0f3
  s_nop 3
  s_mov_b32 s51, 0x20000
  s_add_u32 s38, s46, 1536
L_sp_a2c0f3:
  buffer_load_dword v238, v237, s[32:35], s38 offen sc1
  s_waitcnt vmcnt(0)
  v_cmp_ne_u32 vcc, 1, v238
  s_cbranch_vccz L_ok_a2c0f3
  s_sub_u32 s51, s51, 1
  s_cmp_lg_u32 s51, 0
  s_cbranch_scc1 L_sp_a2c0f3
L_ok_a2c0f3:
  s_add_u32 s39, s71, 8
  s_and_b32 s39, s39, 7
  s_add_u32 s39, s39, 8
  s_xor_b32 s39, s39, s99
  s_lshl_b32 s54, s39, 14
  s_add_u32 s54, s54, s50
  s_add_u32 m0, s68, 81920
  s_nop 0
  buffer_load_dwordx4 v236, s[32:35], s54 offen offset:0 sc1 lds
  buffer_load_dwordx4 v236, s[32:35], s54 offen offset:1024 sc1 lds
  buffer_load_dwordx4 v236, s[32:35], s54 offen offset:2048 sc1 lds
  buffer_load_dwordx4 v236, s[32:35], s54 offen offset:3072 sc1 lds
  s_add_u32 s39, s71, 9
  s_and_b32 s39, s39, 7
  s_add_u32 s39, s39, 8
  s_xor_b32 s39, s39, s99
  s_lshl_b32 s54, s39, 16
  s_add_u32 s54, s54, s49
  s_add_u32 m0, s68, 0
  s_nop 0
  buffer_load_dwordx4 v232, s[24:27], s54 offen offset:0  lds
  buffer_load_dwordx4 v233, s[24:27], s54 offen offset:1024  lds
  buffer_load_dwordx4 v234, s[24:27], s54 offen offset:2048  lds
  buffer_load_dwordx4 v235, s[24:27], s54 offen offset:3072  lds
  s_waitcnt vmcnt(13)
  s_barrier
  s_add_u32 s39, s71, 9
  s_and_b32 s39, s39, 7
  s_add_u32 s39, s39, 8
  s_xor_b32 s39, s39, s99
  s_lshl_b32 s54, s39, 14
  s_add_u32 s54, s54, s50
  s_add_u32 m0, s68, 98304
  s_nop 0
  buffer_load_dwordx4 v236, s[32:35], s54 offen offset:0 sc1 lds
  buffer_load_dwordx4 v236, s[32:35], s54 offen offset:1024 sc1 lds
  buffer_load_dwordx4 v236, s[32:35], s54 offen offset:2048 sc1 lds
  buffer_load_dwordx4 v236, s[32:35], s54 offen offset:3072 sc1 lds
  s_add_u32 s39, s71, 10
  s_and_b32 s39, s39, 7
  s_add_u32 s39, s39, 8
  s_xor_b32 s39, s39, s99
  s_lshl_b32 s54, s39, 16
  s_add_u32 s54, s54, s49
  s_add_u32 m0, s68, 16384
  s_nop 0
  buffer_load_dwordx4 v232, s[24:27], s54 offen offset:0  lds
  buffer_load_dwordx4 v233, s[24:27], s54 offen offset:1024  lds
  buffer_load_dwordx4 v234, s[24:27], s54 offen offset:2048  lds
  buffer_load_dwordx4 v235, s[24:27], s54 offen offset:3072  lds
  s_waitcnt vmcnt(12)
  s_barrier
  s_add_u32 s39, s71, 10
  s_and_b32 s39, s39, 7
  s_add_u32 s39, s39, 8
  s_xor_b32 s39, s39, s99
  s_lshl_b32 s54, s39, 14
  s_add_u32 s54, s54, s50
  s_add_u32 m0, s68, 32768
  s_nop 0
  buffer_load_dwordx4 v236, s[32:35], s54 offen offset:0 sc1 lds
  buffer_load_dwordx4 v236, s[32:35], s54 offen offset:1024 sc1 lds
  buffer_load_dwordx4 v236, s[32:35], s54 offen offset:2048 sc1 lds
  buffer_load_dwordx4 v236, s[32:35], s54 offen offset:3072 sc1 lds
  s_add_u32 s39, s71, 11
  s_and_b32 s39, s39, 7
  s_add_u32 s39, s39, 8
  s_xor_b32 s39, s39, s99
  s_lshl_b32 s54, s39, 16
  s_add_u32 s54, s54, s49
  s_add_u32 m0, s68, 114688
  s_nop 0
  buffer_load_dwordx4 v232, s[24:27], s54 offen offset:0  lds
  buffer_load_dwordx4 v233, s[24:27], s54 offen offset:1024  lds
  buffer_load_dwordx4 v234, s[24:27], s54 offen offset:2048  lds
  buffer_load_dwordx4 v235, s[24:27], s54 offen offset:3072  lds
  s_waitcnt vmcnt(12)
  s_barrier
  s_add_u32 s39, s71, 11
  s_and_b32 s39, s39, 7
  s_add_u32 s39, s39, 8
  s_xor_b32 s39, s39, s99
  s_lshl_b32 s54, s39, 14
  s_add_u32 s54, s54, s50
  s_add_u32 m0, s68, 131072
  s_nop 0
  buffer_load_dwordx4 v236, s[32:35], s54 offen offset:0 sc1 lds
  buffer_load_dwordx4 v236, s[32:35], s54 offen offset:1024 sc1 lds
  buffer_load_dwordx4 v236, s[32:35], s54 offen offset:2048 sc1 lds
  buffer_load_dwordx4 v236, s[32:35], s54 offen offset:3072 sc1 lds
  s_add_u32 s39, s71, 12
  s_and_b32 s39, s39, 7
  s_add_u32 s39, s39, 8
  s_xor_b32 s39, s39, s99
  s_lshl_b32 s54, s39, 16
  s_add_u32 s54, s54, s49
  s_add_u32 m0, s68, 49152
  s_nop 0
  buffer_load_dwordx4 v232, s[24:27], s54 offen offset:0  lds
  buffer_load_dwordx4 v233, s[24:27], s54 offen offset:1024  lds
  buffer_load_dwordx4 v234, s[24:27], s54 offen offset:2048  lds
  buffer_load_dwordx4 v235, s[24:27], s54 offen offset:3072  lds
  s_waitcnt vmcnt(12)
  s_barrier
  s_add_u32 s39, s71, 12
  s_and_b32 s39, s39, 7
  s_add_u32 s39, s39, 8
  s_xor_b32 s39, s39, s99
  s_lshl_b32 s54, s39, 14
  s_add_u32 s54, s54, s50
  s_add_u32 m0, s68, 147456
  s_nop 0
  buffer_load_dwordx4 v236, s[32:35], s54 offen offset:0 sc1 lds
  buffer_load_dwordx4 v236, s[32:35], s54 offen offset:1024 sc1 lds
  buffer_load_dwordx4 v236, s[32:35], s54 offen offset:2048 sc1 lds
  buffer_load_dwordx4 v236, s[32:35], s54 offen offset:3072 sc1 lds
  s_add_u32 s39, s71, 13
  s_and_b32 s39, s39, 7
  s_add_u32 s39, s39, 8
  s_xor_b32 s39, s39, s99
  s_lshl_b32 s54, s39, 16
  s_add_u32 s54, s54, s49
  s_add_u32 m0, s68, 65536
  s_nop 0
  buffer_load_dwordx4 v232, s[24:27], s54 offen offset:0  lds
  buffer_load_dwordx4 v233, s[24:27], s54 offen offset:1024  lds
  buffer_load_dwordx4 v234, s[24:27], s54 offen offset:2048  lds
  buffer_load_dwordx4 v235, s[24:27], s54 offen offset:3072  lds
  s_waitcnt vmcnt(12)
  s_barrier
  s_add_u32 s39, s71, 13
  s_and_b32 s39, s39, 7
  s_add_u32 s39, s39, 8
  s_xor_b32 s39, s39, s99
  s_lshl_b32 s54, s39, 14
  s_add_u32 s54, s54, s50
  s_add_u32 m0, s68, 81920
  s_nop 0
  buffer_load_dwordx4 v236, s[32:35], s54 offen offset:0 sc1 lds
  buffer_load_dwordx4 v236, s[32:35], s54 offen offset:1024 sc1 lds
  buffer_load_dwordx4 v236, s[32:35], s54 offen offset:2048 sc1 lds
  buffer_load_dwordx4 v236, s[32:35], s54 offen offset:3072 sc1 lds
  s_add_u32 s39, s71, 14
  s_and_b32 s39, s39, 7
  s_add_u32 s39, s39, 8
  s_xor_b32 s39, s39, s99
  s_lshl_b32 s54, s39, 16
  s_add_u32 s54, s54, s49
  s_add_u32 m0, s68, 0
  s_nop 0
  buffer_load_dwordx4 v232, s[24:27], s54 offen offset:0  lds
  buffer_load_dwordx4 v233, s[24:27], s54 offen offset:1024  lds
  buffer_load_dwordx4 v234, s[24:27], s54 offen offset:2048  lds
  buffer_load_dwordx4 v235, s[24:27], s54 offen offset:3072  lds
  s_waitcnt vmcnt(12)
  s_barrier
  s_add_u32 s39, s71, 14
  s_and_b32 s39, s39, 7
  s_add_u32 s39, s39, 8
  s_xor_b32 s39, s39, s99
  s_lshl_b32 s54, s39, 14
  s_add_u32 s54, s54, s50
  s_add_u32 m0, s68, 98304
  s_nop 0
  buffer_load_dwordx4 v236, s[32:35], s54 offen offset:0 sc1 lds
  buffer_load_dwordx4 v236, s[32:35], s54 offen offset:1024 sc1 lds
  buffer_load_dwordx4 v236, s[32:35], s54 offen offset:2048 sc1 lds
  buffer_load_dwordx4 v236, s[32:35], s54 offen offset:3072 sc1 lds
  s_add_u32 s39, s71, 15
  s_and_b32 s39, s39, 7
  s_add_u32 s39, s39, 8
  s_xor_b32 s39, s39, s99
  s_lshl_b32 s54, s39, 16
  s_add_u32 s54, s54, s49
  s_add_u32 m0, s68, 16384
  s_nop 0
  buffer_load_dwordx4 v232, s[24:27], s54 offen offset:0  lds
  buffer_load_dwordx4 v233, s[24:27], s54 offen offset:1024  lds
  buffer_load_dwordx4 v234, s[24:27], s54 offen offset:2048  lds
  buffer_load_dwordx4 v235, s[24:27], s54 offen offset:3072  lds
  s_waitcnt vmcnt(12)
  s_barrier
  s_add_u32 s39, s71, 15
  s_and_b32 s39, s39, 7
  s_add_u32 s39, s39, 8
  s_xor_b32 s39, s39, s99
  s_lshl_b32 s54, s39, 14
  s_add_u32 s54, s54, s50
  s_add_u32 m0, s68, 32768
  s_nop 0
  buffer_load_dwordx4 v236, s[32:35], s54 offen offset:0 sc1 lds
  buffer_load_dwordx4 v236, s[32:35], s54 offen offset:1024 sc1 lds
  buffer_load_dwordx4 v236, s[32:35], s54 offen offset:2048 sc1 lds
  buffer_load_dwordx4 v236, s[32:35], s54 offen offset:3072 sc1 lds
  s_waitcnt vmcnt(8)
  s_barrier
  s_waitcnt vmcnt(0)
  s_barrier
  s_endpgm
L_A_stub0:
  s_call_b64 s[64:65], L_A_fix0
  s_branch L_A_back0
L_A_stub1:
  s_call_b64 s[64:65], L_A_fix1
  s_branch L_A_back1
L_A_stub2:
  s_call_b64 s[64:65], L_A_fix0
  s_branch L_A_back2
L_A_stub3:
  s_call_b64 s[64:65], L_A_fix1
  s_branch L_A_back3
L_A_stub4:
  s_call_b64 s[64:65], L_A_fix0
  s_branch L_A_back4
L_A_stub5:
  s_call_b64 s[64:65], L_A_fix1
  s_branch L_A_back5
L_A_stub6:
  s_call_b64 s[64:65], L_A_fix0
  s_branch L_A_back6
L_A_stub7:
  s_call_b64 s[64:65], L_A_fix1
  s_branch L_A_back7
L_A_stub8:
  s_call_b64 s[64:65], L_A_fix0
  s_branch L_A_back8
L_A_stub9:
  s_call_b64 s[64:65], L_A_fix1
  s_branch L_A_back9
L_A_stub10:
  s_call_b64 s[64:65], L_A_fix0
  s_branch L_A_back10
L_A_stub11:
  s_call_b64 s[64:65], L_A_fix1
  s_branch L_A_back11
L_A_stub12:
  s_call_b64 s[64:65], L_A_fix0
  s_branch L_A_back12
L_A_stub13:
  s_call_b64 s[64:65], L_A_fix1
  s_branch L_A_back13
L_A_stub14:
  s_call_b64 s[64:65], L_A_fix0
  s_branch L_A_back14
L_A_stub15:
  s_call_b64 s[64:65], L_A_fix1
  s_branch L_A_back15
L_A_fix0:
  s_nop 15
  s_mov_b32 s67, 0xff800000
  v_sub_f32 v40, v40, v8
  v_sub_f32 v41, v41, v8
  v_sub_f32 v42, v42, v8
  v_sub_f32 v43, v43, v8
  v_sub_f32 v44, v44, v8
  v_sub_f32 v45, v45, v8
  v_sub_f32 v46, v46, v8
  v_sub_f32 v47, v47, v8
  v_sub_f32 v48, v48, v8
  v_sub_f32 v49, v49, v8
  v_sub_f32 v50, v50, v8
  v_sub_f32 v51, v51, v8
  v_sub_f32 v52, v52, v8
  v_sub_f32 v53, v53, v8
  v_sub_f32 v54, v54, v8
  v_sub_f32 v55, v55, v8
  v_max3_f32 v15, v40, v41, v42
  v_max3_f32 v15, v15, v43, v44
  v_max3_f32 v15, v15, v45, v46
  v_max3_f32 v15, v15, v47, v48
  v_max3_f32 v15, v15, v49, v50
  v_max3_f32 v15, v15, v51, v52
  v_max3_f32 v15, v15, v53, v54
  v_max_f32 v15, v15, v55
  v_mov_b32 v1, v15
  s_nop 1
  v_permlane32_swap_b32 v1, v15
  v_max_f32 v15, v15, v1
  v_ceil_f32 v15, v15
  s_cmp_eq_u32 s44, 1
  s_cbranch_scc1 L_A_fixa0
  v_max_f32 v15, 0, v15
L_A_fixa0:
  s_nop 1
  v_sub_f32 v40, v40, v15
  v_sub_f32 v41, v41, v15
  v_sub_f32 v42, v42, v15
  v_sub_f32 v43, v43, v15
  v_sub_f32 v44, v44, v15
  v_sub_f32 v45, v45, v15
  v_sub_f32 v46, v46, v15
  v_sub_f32 v47, v47, v15
  v_sub_f32 v48, v48, v15
  v_sub_f32 v49, v49, v15
  v_sub_f32 v50, v50, v15
  v_sub_f32 v51, v51, v15
  v_sub_f32 v52, v52, v15
  v_sub_f32 v53, v53, v15
  v_sub_f32 v54, v54, v15
  v_sub_f32 v55, v55, v15
  v_add_f32 v8, v8, v15
  s_cbranch_scc1 L_A_fixd0
  v_exp_f32 v15, -v15
  s_nop 0
  v_mul_f32 v9, v9, v15
  v_mul_f32 v10, v10, v15
  v_mul_f32 v104, v104, v15
  v_mul_f32 v105, v105, v15
  v_mul_f32 v106, v106, v15
  v_mul_f32 v107, v107, v15
  v_mul_f32 v108, v108, v15
  v_mul_f32 v109, v109, v15
  v_mul_f32 v110, v110, v15
  v_mul_f32 v111, v111, v15
  v_mul_f32 v112, v112, v15
  v_mul_f32 v113, v113, v15
  v_mul_f32 v114, v114, v15
  v_mul_f32 v115, v115, v15
  v_mul_f32 v116, v116, v15
  v_mul_f32 v117, v117, v15
  v_mul_f32 v118, v118, v15
  v_mul_f32 v119, v119, v15
  v_mul_f32 v120, v120, v15
  v_mul_f32 v121, v121, v15
  v_mul_f32 v122, v122, v15
  v_mul_f32 v123, v123, v15
  v_mul_f32 v124, v124, v15
  v_mul_f32 v125, v125, v15
  v_mul_f32 v126, v126, v15
  v_mul_f32 v127, v127, v15
  v_mul_f32 v128, v128, v15
  v_mul_f32 v129, v129, v15
  v_mul_f32 v130, v130, v15
  v_mul_f32 v131, v131, v15
  v_mul_f32 v132, v132, v15
  v_mul_f32 v133, v133, v15
  v_mul_f32 v134, v134, v15
  v_mul_f32 v135, v135, v15
  v_mul_f32 v136, v136, v15
  v_mul_f32 v137, v137, v15
  v_mul_f32 v138, v138, v15
  v_mul_f32 v139, v139, v15
  v_mul_f32 v140, v140, v15
  v_mul_f32 v141, v141, v15
  v_mul_f32 v142, v142, v15
  v_mul_f32 v143, v143, v15
  v_mul_f32 v144, v144, v15
  v_mul_f32 v145, v145, v15
  v_mul_f32 v146, v146, v15
  v_mul_f32 v147, v147, v15
  v_mul_f32 v148, v148, v15
  v_mul_f32 v149, v149, v15
  v_mul_f32 v150, v150, v15
  v_mul_f32 v151, v151, v15
  v_mul_f32 v152, v152, v15
  v_mul_f32 v153, v153, v15
  v_mul_f32 v154, v154, v15
  v_mul_f32 v155, v155, v15
  v_mul_f32 v156, v156, v15
  v_mul_f32 v157, v157, v15
  v_mul_f32 v158, v158, v15
  v_mul_f32 v159, v159, v15
  v_mul_f32 v160, v160, v15
  v_mul_f32 v161, v161, v15
  v_mul_f32 v162, v162, v15
  v_mul_f32 v163, v163, v15
  v_mul_f32 v164, v164, v15
  v_mul_f32 v165, v165, v15
  v_mul_f32 v166, v166, v15
  v_mul_f32 v167, v167, v15
  v_lshlrev_b32 v1, 16, v56
  v_and_b32 v56, 0xffff0000, v56
  v_mul_f32 v1, v1, v15
  v_mul_f32 v56, v56, v15
  v_cvt_pk_bf16_f32 v56, v1, v56
  v_lshlrev_b32 v1, 16, v57
  v_and_b32 v57, 0xffff0000, v57
  v_mul_f32 v1, v1, v15
  v_mul_f32 v57, v57, v15
  v_cvt_pk_bf16_f32 v57, v1, v57
  v_lshlrev_b32 v1, 16, v58
  v_and_b32 v58, 0xffff0000, v58
  v_mul_f32 v1, v1, v15
  v_mul_f32 v58, v58, v15
  v_cvt_pk_bf16_f32 v58, v1, v58
  v_lshlrev_b32 v1, 16, v59
  v_and_b32 v59, 0xffff0000, v59
  v_mul_f32 v1, v1, v15
  v_mul_f32 v59, v59, v15
  v_cvt_pk_bf16_f32 v59, v1, v59
  v_lshlrev_b32 v1, 16, v60
  v_and_b32 v60, 0xffff0000, v60
  v_mul_f32 v1, v1, v15
  v_mul_f32 v60, v60, v15
  v_cvt_pk_bf16_f32 v60, v1, v60
  v_lshlrev_b32 v1, 16, v61
  v_and_b32 v61, 0xffff0000, v61
  v_mul_f32 v1, v1, v15
  v_mul_f32 v61, v61, v15
  v_cvt_pk_bf16_f32 v61, v1, v61
  v_lshlrev_b32 v1, 16, v62
  v_and_b32 v62, 0xffff0000, v62
  v_mul_f32 v1, v1, v15
  v_mul_f32 v62, v62, v15
  v_cvt_pk_bf16_f32 v62, v1, v62
  v_lshlrev_b32 v1, 16, v63
  v_and_b32 v63, 0xffff0000, v63
  v_mul_f32 v1, v1, v15
  v_mul_f32 v63, v63, v15
  v_cvt_pk_bf16_f32 v63, v1, v63
L_A_fixd0:
  s_nop 3
  s_setpc_b64 s[64:65]
L_A_fix1:
  s_nop 15
  s_mov_b32 s67, 0xff800000
  v_sub_f32 v56, v56, v8
  v_sub_f32 v57, v57, v8
  v_sub_f32 v58, v58, v8
  v_sub_f32 v59, v59, v8
  v_sub_f32 v60, v60, v8
  v_sub_f32 v61, v61, v8
  v_sub_f32 v62, v62, v8
  v_sub_f32 v63, v63, v8
  v_sub_f32 v64, v64, v8
  v_sub_f32 v65, v65, v8
  v_sub_f32 v66, v66, v8
  v_sub_f32 v67, v67, v8
  v_sub_f32 v68, v68, v8
  v_sub_f32 v69, v69, v8
  v_sub_f32 v70, v70, v8
  v_sub_f32 v71, v71, v8
  v_max3_f32 v15, v56, v57, v58
  v_max3_f32 v15, v15, v59, v60
  v_max3_f32 v15, v15, v61, v62
  v_max3_f32 v15, v15, v63, v64
  v_max3_f32 v15, v15, v65, v66
  v_max3_f32 v15, v15, v67, v68
  v_max3_f32 v15, v15, v69, v70
  v_max_f32 v15, v15, v71
  v_mov_b32 v1, v15
  s_nop 1
  v_permlane32_swap_b32 v1, v15
  v_max_f32 v15, v15, v1
  v_ceil_f32 v15, v15
  s_cmp_eq_u32 s44, 1
  s_cbranch_scc1 L_A_fixa1
  v_max_f32 v15, 0, v15
L_A_fixa1:
  s_nop 1
  v_sub_f32 v56, v56, v15
  v_sub_f32 v57, v57, v15
  v_sub_f32 v58, v58, v15
  v_sub_f32 v59, v59, v15
  v_sub_f32 v60, v60, v15
  v_sub_f32 v61, v61, v15
  v_sub_f32 v62, v62, v15
  v_sub_f32 v63, v63, v15
  v_sub_f32 v64, v64, v15
  v_sub_f32 v65, v65, v15
  v_sub_f32 v66, v66, v15
  v_sub_f32 v67, v67, v15
  v_sub_f32 v68, v68, v15
  v_sub_f32 v69, v69, v15
  v_sub_f32 v70, v70, v15
  v_sub_f32 v71, v71, v15
  v_add_f32 v8, v8, v15
  s_cbranch_scc1 L_A_fixd1
  v_exp_f32 v15, -v15
  s_nop 0
  v_mul_f32 v9, v9, v15
  v_mul_f32 v10, v10, v15
  v_mul_f32 v104, v104, v15
  v_mul_f32 v105, v105, v15
  v_mul_f32 v106, v106, v15
  v_mul_f32 v107, v107, v15
  v_mul_f32 v108, v108, v15
  v_mul_f32 v109, v109, v15
  v_mul_f32 v110, v110, v15
  v_mul_f32 v111, v111, v15
  v_mul_f32 v112, v112, v15
  v_mul_f32 v113, v113, v15
  v_mul_f32 v114, v114, v15
  v_mul_f32 v115, v115, v15
  v_mul_f32 v116, v116, v15
  v_mul_f32 v117, v117, v15
  v_mul_f32 v118, v118, v15
  v_mul_f32 v119, v119, v15
  v_mul_f32 v120, v120, v15
  v_mul_f32 v121, v121, v15
  v_mul_f32 v122, v122, v15
  v_mul_f32 v123, v123, v15
  v_mul_f32 v124, v124, v15
  v_mul_f32 v125, v125, v15
  v_mul_f32 v126, v126, v15
  v_mul_f32 v127, v127, v15
  v_mul_f32 v128, v128, v15
  v_mul_f32 v129, v129, v15
  v_mul_f32 v130, v130, v15
  v_mul_f32 v131, v131, v15
  v_mul_f32 v132, v132, v15
  v_mul_f32 v133, v133, v15
  v_mul_f32 v134, v134, v15
  v_mul_f32 v135, v135, v15
  v_mul_f32 v136, v136, v15
  v_mul_f32 v137, v137, v15
  v_mul_f32 v138, v138, v15
  v_mul_f32 v139, v139, v15
  v_mul_f32 v140, v140, v15
  v_mul_f32 v141, v141, v15
  v_mul_f32 v142, v142, v15
  v_mul_f32 v143, v143, v15
  v_mul_f32 v144, v144, v15
  v_mul_f32 v145, v145, v15
  v_mul_f32 v146, v146, v15
  v_mul_f32 v147, v147, v15
  v_mul_f32 v148, v148, v15
  v_mul_f32 v149, v149, v15
  v_mul_f32 v150, v150, v15
  v_mul_f32 v151, v151, v15
  v_mul_f32 v152, v152, v15
  v_mul_f32 v153, v153, v15
  v_mul_f32 v154, v154, v15
  v_mul_f32 v155, v155, v15
  v_mul_f32 v156, v156, v15
  v_mul_f32 v157, v157, v15
  v_mul_f32 v158, v158, v15
  v_mul_f32 v159, v159, v15
  v_mul_f32 v160, v160, v15
  v_mul_f32 v161, v161, v15
  v_mul_f32 v162, v162, v15
  v_mul_f32 v163, v163, v15
  v_mul_f32 v164, v164, v15
  v_mul_f32 v165, v165, v15
  v_mul_f32 v166, v166, v15
  v_mul_f32 v167, v167, v15
  v_lshlrev_b32 v1, 16, v40
  v_and_b32 v40, 0xffff0000, v40
  v_mul_f32 v1, v1, v15
  v_mul_f32 v40, v40, v15
  v_cvt_pk_bf16_f32 v40, v1, v40
  v_lshlrev_b32 v1, 16, v41
  v_and_b32 v41, 0xffff0000, v41
  v_mul_f32 v1, v1, v15
  v_mul_f32 v41, v41, v15
  v_cvt_pk_bf16_f32 v41, v1, v41
  v_lshlrev_b32 v1, 16, v42
  v_and_b32 v42, 0xffff0000, v42
  v_mul_f32 v1, v1, v15
  v_mul_f32 v42, v42, v15
  v_cvt_pk_bf16_f32 v42, v1, v42
  v_lshlrev_b32 v1, 16, v43
  v_and_b32 v43, 0xffff0000, v43
  v_mul_f32 v1, v1, v15
  v_mul_f32 v43, v43, v15
  v_cvt_pk_bf16_f32 v43, v1, v43
  v_lshlrev_b32 v1, 16, v44
  v_and_b32 v44, 0xffff0000, v44
  v_mul_f32 v1, v1, v15
  v_mul_f32 v44, v44, v15
  v_cvt_pk_bf16_f32 v44, v1, v44
  v_lshlrev_b32 v1, 16, v45
  v_and_b32 v45, 0xffff0000, v45
  v_mul_f32 v1, v1, v15
  v_mul_f32 v45, v45, v15
  v_cvt_pk_bf16_f32 v45, v1, v45
  v_lshlrev_b32 v1, 16, v46
  v_and_b32 v46, 0xffff0000, v46
  v_mul_f32 v1, v1, v15
  v_mul_f32 v46, v46, v15
  v_cvt_pk_bf16_f32 v46, v1, v46
  v_lshlrev_b32 v1, 16, v47
  v_and_b32 v47, 0xffff0000, v47
  v_mul_f32 v1, v1, v15
  v_mul_f32 v47, v47, v15
  v_cvt_pk_bf16_f32 v47, v1, v47
L_A_fixd1:
  s_nop 3
  s_setpc_b64 s[64:65]
L_exit:
  s_endpgm
.section .rodata,"a"
.p2align 6
.amdhsa_kernel standalone__mha_block_cached__near_ridge_kernel
  .amdhsa_next_free_vgpr 256
  .amdhsa_next_free_sgpr 102
  .amdhsa_accum_offset 256
  .amdhsa_group_segment_fixed_size 0
  .amdhsa_kernarg_size 64
  .amdhsa_user_sgpr_count 2
  .amdhsa_user_sgpr_kernarg_segment_ptr 1
  .amdhsa_system_sgpr_workgroup_id_x 1
.end_amdhsa_kernel
```
